```python
import torch

def _softmax(x, axis=-1):
    return torch.softmax(x, dim=axis)
def _gelu(x):
    return torch.nn.functional.gelu(x, approximate="tanh")
def _silu(x):
    return torch.nn.functional.silu(x)
def _sigmoid(x):
    return torch.sigmoid(x)
def _layernorm(x, axis=-1, eps=1e-5):
    m = x.mean(dim=axis, keepdim=True)
    v = x.var(dim=axis, keepdim=True, unbiased=False)
    return (x - m) / torch.sqrt(v + eps)
def _scatter_add(tgt, idx, src, axis=0):
    return tgt.clone().index_add_(axis, idx, src)
def _segment_sum(src, seg, n):
    out = torch.zeros((n,) + src.shape[1:], dtype=src.dtype)
    return out.index_add_(0, seg, src)
def _pad(x, pw):
    flat = tuple(v for pair in reversed(pw) for v in pair)
    return torch.nn.functional.pad(x, flat)

kernel_name = 'concat_heads__mha_block_cached__gqa_block_cached__near_ridge'

def setup_inputs():

    _w = (lambda a: (lambda t: t.to(torch.bfloat16) if t.is_floating_point() else t)(torch.as_tensor(a)))
    def _A_setup():
        B, Sq, D = 8, 144, 640
        H, Sk, Dh = 32, 512, 128
        return {
            "x": _w((lambda *s: torch.randn(*s, dtype=torch.bfloat16) * 0.8)(B, Sq, D)),
            "k_cache": _w((lambda *s: torch.randn(*s, dtype=torch.bfloat16) * 0.8)(B, H, Sk, Dh)),
            "v_cache": _w((lambda *s: torch.randn(*s, dtype=torch.bfloat16) * 0.05)(B, H, Sk, Dh)),
            "wq": _w((lambda *s: torch.randn(*s, dtype=torch.bfloat16) * 0.8)(D, H * Dh) * (D ** -0.5)),
            "wo": _w((lambda *s: torch.randn(*s, dtype=torch.bfloat16) * 0.05)(H * Dh, D) * ((H * Dh) ** -0.5)),
        }
    _A_in = _A_setup()

    def _B_setup():
        B, Sq, D = 8, 144, 640
        Hq, Hkv, Sk, Dh = 32, 32, 512, 128
        assert Hq % Hkv == 0, (Hq, Hkv)
        return {
            "x": _w((lambda *s: torch.randn(*s, dtype=torch.bfloat16) * 0.8)(B, Sq, D)),
            "k_cache": _w((lambda *s: torch.randn(*s, dtype=torch.bfloat16) * 0.8)(B, Hkv, Sk, Dh)),
            "v_cache": _w((lambda *s: torch.randn(*s, dtype=torch.bfloat16) * 0.05)(B, Hkv, Sk, Dh)),
            "wq": _w((lambda *s: torch.randn(*s, dtype=torch.bfloat16) * 0.8)(D, Hq * Dh) * (D ** -0.5)),
            "wo": _w((lambda *s: torch.randn(*s, dtype=torch.bfloat16) * 0.05)(Hq * Dh, D) * ((Hq * Dh) ** -0.5)),
        }
    _B_in = _B_setup()

    return {
        "A_x": _A_in["x"],
        "A_k_cache": _A_in["k_cache"],
        "A_v_cache": _A_in["v_cache"],
        "A_wq": _A_in["wq"],
        "A_wo": _A_in["wo"],
        "B_x": _B_in["x"],
        "B_k_cache": _B_in["k_cache"],
        "B_v_cache": _B_in["v_cache"],
        "B_wq": _B_in["wq"],
        "B_wo": _B_in["wo"],
    }

def reference(A_x, A_k_cache, A_v_cache, A_wq, A_wo, B_x, B_k_cache, B_v_cache, B_wq, B_wo):
    def _A_ref(x, k_cache, v_cache, wq, wo):
        B, Sq, D = x.shape
        H, Dh = 32, 128
        q = (lambda x, *d: x.permute(*d))((x @ wq).reshape(B, Sq, H, Dh), 0, 2, 1, 3)
        scores = torch.einsum("bhqd,bhkd->bhqk", q, k_cache) * (Dh ** -0.5)
        p = _softmax(scores, axis=-1)
        o = torch.einsum("bhqk,bhkd->bhqd", p, v_cache)
        return (lambda x, *d: x.permute(*d))(o, 0, 2, 1, 3).reshape(B, Sq, H * Dh) @ wo

    def _B_ref(x, k_cache, v_cache, wq, wo):
        B, Sq, D = x.shape
        Hq, Dh = 32, 128
        Hkv = k_cache.shape[1]
        rep = Hq // Hkv
        q = (lambda x, *d: x.permute(*d))((x @ wq).reshape(B, Sq, Hq, Dh), 0, 2, 1, 3)
        k = (lambda x, n, axis: torch.repeat_interleave(x, n, dim=axis))(k_cache, rep, axis=1)
        v = (lambda x, n, axis: torch.repeat_interleave(x, n, dim=axis))(v_cache, rep, axis=1)
        scores = torch.einsum("bhqd,bhkd->bhqk", q, k) * (Dh ** -0.5)
        p = _softmax(scores, axis=-1)
        o = torch.einsum("bhqk,bhkd->bhqd", p, v)
        return (lambda x, *d: x.permute(*d))(o, 0, 2, 1, 3).reshape(B, Sq, Hq * Dh) @ wo

    a = _A_ref(A_x, A_k_cache, A_v_cache, A_wq, A_wo)
    b = _B_ref(B_x, B_k_cache, B_v_cache, B_wq, B_wo)
    return torch.concatenate([a, b], axis=-1)
```

```asm
; @launch kernel=k1_attn_kernel grid=(256,1,1) block=(512,1,1) lds=163840
; @launch kernel=k2_oproj_kernel grid=(240,1,1) block=(512,1,1) lds=131072
.amdgcn_target "amdgcn-amd-amdhsa--gfx950"
.text
.globl k1_attn_kernel
.p2align 8
.type k1_attn_kernel,@function
k1_attn_kernel:
    s_cmp_ge_u32 s2, 256
    s_cbranch_scc1 L_k1_end
    s_load_dwordx16 s[16:31], s[0:1], 0
    s_load_dwordx4 s[32:35], s[0:1], 64
    s_load_dwordx2 s[36:37], s[0:1], 96
    v_and_b32 v1, 63, v0
    v_lshrrev_b32 v13, 6, v0
    v_and_b32 v2, 15, v0
    v_lshrrev_b32 v3, 4, v1
    v_readfirstlane_b32 s73, v13
    s_and_b32 s3, s2, 7
    s_lshr_b32 s38, s2, 3
    s_lshr_b32 s5, s3, 2
    s_bfe_u32 s6, s3, 0x10001
    s_lshl_b32 s6, s6, 2
    s_and_b32 s4, s38, 3
    s_add_u32 s6, s6, s4
    s_and_b32 s3, s3, 1
    s_lshl_b32 s3, s3, 3
    s_lshr_b32 s4, s38, 2
    s_add_u32 s3, s3, s4
    s_lshl_b32 s3, s3, 1
    s_lshr_b32 s39, s73, 2
    s_add_u32 s3, s3, s39
    s_and_b32 s60, s73, 3
    s_lshl_b32 s4, s5, 3
    s_add_u32 s4, s4, s6
    s_waitcnt lgkmcnt(0)
    s_cmp_eq_u32 s5, 0
    s_cselect_b64 s[8:9], s[16:17], s[26:27]
    s_cselect_b64 s[10:11], s[18:19], s[28:29]
    s_cselect_b64 s[12:13], s[20:21], s[30:31]
    s_cselect_b64 s[14:15], s[22:23], s[32:33]
    s_cselect_b64 s[34:35], s[24:25], s[34:35]
    s_mul_i32 s7, s6, 184320
    s_add_u32 s40, s8, s7
    s_addc_u32 s41, s9, 0
    s_and_b32 s41, s41, 0xffff
    s_mov_b32 s42, 184320
    s_mov_b32 s43, 0x20000
    s_lshl_b32 s7, s3, 8
    s_add_u32 s44, s14, s7
    s_addc_u32 s45, s15, 0
    s_and_b32 s45, s45, 0xffff
    s_sub_u32 s46, 5242880, s7
    s_mov_b32 s47, 0x20000
    s_lshl_b32 s7, s6, 5
    s_add_u32 s7, s7, s3
    s_lshl_b32 s7, s7, 17
    s_add_u32 s48, s10, s7
    s_addc_u32 s49, s11, 0
    s_and_b32 s49, s49, 0xffff
    s_mov_b32 s50, 131072
    s_mov_b32 s51, 0x20000
    s_add_u32 s52, s12, s7
    s_addc_u32 s53, s13, 0
    s_and_b32 s53, s53, 0xffff
    s_mov_b32 s54, 131072
    s_mov_b32 s55, 0x20000
    s_lshl_b32 s7, s4, 5
    s_add_u32 s7, s7, s3
    s_mul_i32 s7, s7, 36864
    s_add_u32 s56, s36, s7
    s_addc_u32 s57, s37, 0
    s_and_b32 s57, s57, 0xffff
    s_mov_b32 s58, 36864
    s_mov_b32 s59, 0x20000
    s_mul_i32 s72, s39, 81920
    s_add_u32 s97, s72, 81920
    s_lshl_b32 s61, s60, 12
    s_lshl_b32 s76, s60, 11
    s_mov_b32 s62, 0x3e0293ee
    s_lshl_b32 s69, s60, 13
    s_add_u32 s70, s69, 4096
    s_lshl_b32 s71, s60, 10
    s_add_u32 s71, s71, 32768
    s_mul_i32 s64, s73, 10240
    s_add_u32 s65, s64, 81920
    s_and_b32 s7, s73, 1
    s_add_u32 s7, s7, 16
    s_mul_i32 s66, s7, 10240
    s_lshl_b32 s93, s73, 10
    s_add_u32 s94, s93, 8192
    s_lshl_b32 s95, s7, 10
    v_lshlrev_b32 v13, 1, v3
    v_xor_b32 v13, v2, v13
    v_lshlrev_b32 v13, 4, v13
    v_lshlrev_b32 v14, 8, v3
    v_add_u32 v14, s61, v14
    v_add_u32 v4, v13, v14
    s_and_b32 s7, s60, 1
    s_lshl_b32 s7, s7, 3
    v_lshlrev_b32 v13, 1, v3
    v_xor_b32 v13, s7, v13
    v_xor_b32 v13, v2, v13
    v_lshlrev_b32 v13, 4, v13
    s_lshl_b32 s7, s60, 16
    v_lshlrev_b32 v14, 13, v3
    v_add_u32 v14, s7, v14
    v_add_u32 v6, v13, v14
    v_add_u32 v7, 31744, v6
    s_and_b32 s7, s73, 1
    s_lshl_b32 s7, s7, 2
    v_lshrrev_b32 v13, 4, v1
    v_add_u32 v13, s7, v13
    v_and_b32 v14, 7, v1
    v_xor_b32 v13, v13, v14
    v_lshlrev_b32 v13, 4, v13
    v_lshrrev_b32 v14, 3, v1
    v_mul_u32_u24 v14, 1280, v14
    v_add_u32 v5, v13, v14
    v_and_b32 v13, 7, v2
    v_lshlrev_b32 v13, 1, v13
    v_lshrrev_b32 v14, 3, v2
    v_or_b32 v13, v13, v14
    v_lshrrev_b32 v14, 1, v3
    v_xor_b32 v13, v13, v14
    v_lshlrev_b32 v13, 4, v13
    v_lshlrev_b32 v14, 8, v2
    v_add_u32 v13, v13, v14
    v_and_b32 v14, 1, v3
    v_lshlrev_b32 v15, 3, v14
    v_add_u32 v8, v13, v15
    v_lshrrev_b32 v13, 2, v1
    v_and_b32 v13, 3, v13
    v_lshlrev_b32 v14, 2, v14
    v_add_u32 v14, v13, v14
    v_lshlrev_b32 v14, 5, v14
    v_and_b32 v15, 3, v1
    v_lshlrev_b32 v15, 3, v15
    v_add_u32 v14, v14, v15
    v_lshlrev_b32 v15, 3, v3
    v_add_u32 v15, v15, v13
    v_lshlrev_b32 v15, 8, v15
    v_add_u32 v10, v15, v14
    v_lshlrev_b32 v15, 2, v3
    v_add_u32 v15, v15, v13
    v_lshlrev_b32 v15, 8, v15
    v_lshrrev_b32 v13, 1, v3
    v_lshlrev_b32 v13, 4, v13
    v_xor_b32 v14, v14, v13
    v_add_u32 v9, v15, v14
    v_lshrrev_b32 v13, 1, v2
    v_xor_b32 v13, v13, v3
    v_lshlrev_b32 v13, 4, v13
    v_lshlrev_b32 v14, 7, v2
    v_add_u32 v11, v13, v14
    v_lshlrev_b32 v12, 4, v1
    v_mov_b32 v64, 0
    v_mov_b32 v65, 0
    v_mov_b32 v66, 0
    v_mov_b32 v67, 0
    v_mov_b32 v68, 0
    v_mov_b32 v69, 0
    v_mov_b32 v70, 0
    v_mov_b32 v71, 0
    v_mov_b32 v72, 0
    v_mov_b32 v73, 0
    v_mov_b32 v74, 0
    v_mov_b32 v75, 0
    v_mov_b32 v76, 0
    v_mov_b32 v77, 0
    v_mov_b32 v78, 0
    v_mov_b32 v79, 0
    v_mov_b32 v80, 0
    v_mov_b32 v81, 0
    v_mov_b32 v82, 0
    v_mov_b32 v83, 0
    v_mov_b32 v84, 0
    v_mov_b32 v85, 0
    v_mov_b32 v86, 0
    v_mov_b32 v87, 0
    v_mov_b32 v88, 0
    v_mov_b32 v89, 0
    v_mov_b32 v90, 0
    v_mov_b32 v91, 0
    v_mov_b32 v92, 0
    v_mov_b32 v93, 0
    v_mov_b32 v94, 0
    v_mov_b32 v95, 0
    v_mov_b32 v96, 0
    v_mov_b32 v97, 0
    v_mov_b32 v98, 0
    v_mov_b32 v99, 0
    v_mov_b32 v100, 0
    v_mov_b32 v101, 0
    v_mov_b32 v102, 0
    v_mov_b32 v103, 0
    v_mov_b32 v104, 0
    v_mov_b32 v105, 0
    v_mov_b32 v106, 0
    v_mov_b32 v107, 0
    v_mov_b32 v108, 0
    v_mov_b32 v109, 0
    v_mov_b32 v110, 0
    v_mov_b32 v111, 0
    v_mov_b32 v112, 0
    v_mov_b32 v113, 0
    v_mov_b32 v114, 0
    v_mov_b32 v115, 0
    v_mov_b32 v116, 0
    v_mov_b32 v117, 0
    v_mov_b32 v118, 0
    v_mov_b32 v119, 0
    v_mov_b32 v120, 0
    v_mov_b32 v121, 0
    v_mov_b32 v122, 0
    v_mov_b32 v123, 0
    v_mov_b32 v124, 0
    v_mov_b32 v125, 0
    v_mov_b32 v126, 0
    v_mov_b32 v127, 0
    v_mov_b32 v128, 0
    v_mov_b32 v129, 0
    v_mov_b32 v130, 0
    v_mov_b32 v131, 0
    v_mov_b32 v132, 0
    v_mov_b32 v133, 0
    v_mov_b32 v134, 0
    v_mov_b32 v135, 0
    s_mov_b32 s67, 0
    s_mov_b32 s92, 0
    s_mov_b32 s96, s72
    s_mov_b32 s75, s72
    s_mov_b32 s74, 24576
    s_mov_b32 s39, 106496
    s_mov_b32 s63, 10
    s_nop 3
    s_cmp_ge_u32 s73, 4
    s_cbranch_scc1 L_k1_roleBC
    s_add_u32 m0, s76, s96
    s_nop 0
    buffer_load_dwordx4 v6, s[44:47], s67 offen lds
    buffer_load_dwordx4 v7, s[44:47], s67 offen offset:1024 lds
    s_add_u32 m0, m0, 81920
    s_add_u32 s68, s67, 256
    buffer_load_dwordx4 v6, s[44:47], s68 offen lds
    buffer_load_dwordx4 v7, s[44:47], s68 offen offset:1024 lds
    s_add_u32 s67, s67, 262144
    s_add_u32 s96, s96, 8192
    s_sub_u32 s7, s96, s72
    s_cmp_eq_u32 s7, 24576
    s_cselect_b32 s96, s72, s96
    s_add_u32 m0, s76, s96
    s_nop 0
    buffer_load_dwordx4 v6, s[44:47], s67 offen lds
    buffer_load_dwordx4 v7, s[44:47], s67 offen offset:1024 lds
    s_add_u32 m0, m0, 81920
    s_add_u32 s68, s67, 256
    buffer_load_dwordx4 v6, s[44:47], s68 offen lds
    buffer_load_dwordx4 v7, s[44:47], s68 offen offset:1024 lds
    s_add_u32 s67, s67, 262144
    s_add_u32 s96, s96, 8192
    s_sub_u32 s7, s96, s72
    s_cmp_eq_u32 s7, 24576
    s_cselect_b32 s96, s72, s96
    s_waitcnt vmcnt(4)
    s_barrier
    v_add_u32 v247, s74, v11
    v_add_u32 v246, s61, v247
    v_add_u32 v228, s75, v10
    v_xor_b32 v229, 32, v228
    v_xor_b32 v230, 64, v228
    v_xor_b32 v231, 96, v228
    v_xor_b32 v232, 128, v228
    v_xor_b32 v233, 160, v228
    v_xor_b32 v234, 192, v228
    v_xor_b32 v235, 224, v228
    s_lshl_b32 s7, s60, 6
    v_xor_b32 v244, s7, v228
    v_xor_b32 v245, 32, v244
    s_add_u32 s75, s75, 8192
    s_sub_u32 s7, s75, s72
    s_cmp_eq_u32 s7, 24576
    s_cselect_b32 s75, s72, s75
    ds_read_b128 v[136:139], v246 offset:0
    ds_read_b128 v[140:143], v246 offset:2048
    ds_read_b128 v[144:147], v247 offset:16384
    ds_read_b64_tr_b16 v[196:197], v228 offset:0
    ds_read_b64_tr_b16 v[198:199], v228 offset:1024
    ds_read_b64_tr_b16 v[200:201], v229 offset:0
    ds_read_b64_tr_b16 v[202:203], v229 offset:1024
    ds_read_b64_tr_b16 v[204:205], v230 offset:0
    ds_read_b64_tr_b16 v[206:207], v230 offset:1024
    ds_read_b64_tr_b16 v[208:209], v231 offset:0
    ds_read_b64_tr_b16 v[210:211], v231 offset:1024
    ds_read_b64_tr_b16 v[212:213], v232 offset:0
    ds_read_b64_tr_b16 v[214:215], v232 offset:1024
    ds_read_b64_tr_b16 v[216:217], v233 offset:0
    ds_read_b64_tr_b16 v[218:219], v233 offset:1024
    ds_read_b64_tr_b16 v[220:221], v234 offset:0
    ds_read_b64_tr_b16 v[222:223], v234 offset:1024
    ds_read_b64_tr_b16 v[224:225], v235 offset:0
    ds_read_b64_tr_b16 v[226:227], v235 offset:1024
    ds_read_b64_tr_b16 v[184:185], v244 offset:0
    ds_read_b64_tr_b16 v[186:187], v244 offset:1024
    ds_read_b64_tr_b16 v[188:189], v245 offset:0
    ds_read_b64_tr_b16 v[190:191], v245 offset:1024
    s_add_u32 m0, s76, s96
    s_nop 0
    buffer_load_dwordx4 v6, s[44:47], s67 offen lds
    buffer_load_dwordx4 v7, s[44:47], s67 offen offset:1024 lds
    s_add_u32 m0, m0, 81920
    s_add_u32 s68, s67, 256
    buffer_load_dwordx4 v6, s[44:47], s68 offen lds
    buffer_load_dwordx4 v7, s[44:47], s68 offen offset:1024 lds
    s_add_u32 s67, s67, 262144
    s_add_u32 s96, s96, 8192
    s_sub_u32 s7, s96, s72
    s_cmp_eq_u32 s7, 24576
    s_cselect_b32 s96, s72, s96
    s_nop 7
L_k1_qA:
    s_waitcnt lgkmcnt(0)
    s_waitcnt vmcnt(4)
    s_barrier
    v_xor_b32 v246, 64, v246
    v_xor_b32 v247, 64, v247
    v_add_u32 v228, s75, v10
    v_xor_b32 v229, 32, v228
    v_xor_b32 v230, 64, v228
    v_xor_b32 v231, 96, v228
    v_xor_b32 v232, 128, v228
    v_xor_b32 v233, 160, v228
    v_xor_b32 v234, 192, v228
    v_xor_b32 v235, 224, v228
    s_lshl_b32 s7, s60, 6
    v_xor_b32 v244, s7, v228
    v_xor_b32 v245, 32, v244
    s_add_u32 s75, s75, 8192
    s_sub_u32 s7, s75, s72
    s_cmp_eq_u32 s7, 24576
    s_cselect_b32 s75, s72, s75
    ds_read_b128 v[148:151], v246 offset:0
    ds_read_b128 v[152:155], v246 offset:2048
    ds_read_b128 v[156:159], v247 offset:16384
    ds_read_b64_tr_b16 v[16:17], v228 offset:0
    ds_read_b64_tr_b16 v[18:19], v228 offset:1024
    ds_read_b64_tr_b16 v[20:21], v229 offset:0
    ds_read_b64_tr_b16 v[22:23], v229 offset:1024
    ds_read_b64_tr_b16 v[24:25], v230 offset:0
    ds_read_b64_tr_b16 v[26:27], v230 offset:1024
    ds_read_b64_tr_b16 v[28:29], v231 offset:0
    ds_read_b64_tr_b16 v[30:31], v231 offset:1024
    ds_read_b64_tr_b16 v[32:33], v232 offset:0
    ds_read_b64_tr_b16 v[34:35], v232 offset:1024
    ds_read_b64_tr_b16 v[36:37], v233 offset:0
    ds_read_b64_tr_b16 v[38:39], v233 offset:1024
    ds_read_b64_tr_b16 v[40:41], v234 offset:0
    ds_read_b64_tr_b16 v[42:43], v234 offset:1024
    ds_read_b64_tr_b16 v[44:45], v235 offset:0
    ds_read_b64_tr_b16 v[46:47], v235 offset:1024
    ds_read_b64_tr_b16 v[48:49], v244 offset:0
    ds_read_b64_tr_b16 v[50:51], v244 offset:1024
    ds_read_b64_tr_b16 v[52:53], v245 offset:0
    ds_read_b64_tr_b16 v[54:55], v245 offset:1024
    s_mov_b32 s7, s74
    s_mov_b32 s74, s39
    s_mov_b32 s39, s7
    v_mfma_f32_16x16x32_bf16 v[64:67], v[196:199], v[136:139], v[64:67]
    v_mfma_f32_16x16x32_bf16 v[96:99], v[196:199], v[140:143], v[96:99]
    v_mfma_f32_16x16x32_bf16 v[68:71], v[200:203], v[136:139], v[68:71]
    v_mfma_f32_16x16x32_bf16 v[100:103], v[200:203], v[140:143], v[100:103]
    s_add_u32 m0, s76, s96
    s_nop 0
    buffer_load_dwordx4 v6, s[44:47], s67 offen lds
    v_mfma_f32_16x16x32_bf16 v[72:75], v[204:207], v[136:139], v[72:75]
    v_mfma_f32_16x16x32_bf16 v[104:107], v[204:207], v[140:143], v[104:107]
    buffer_load_dwordx4 v7, s[44:47], s67 offen offset:1024 lds
    v_mfma_f32_16x16x32_bf16 v[76:79], v[208:211], v[136:139], v[76:79]
    v_mfma_f32_16x16x32_bf16 v[108:111], v[208:211], v[140:143], v[108:111]
    s_add_u32 m0, m0, 81920
    s_add_u32 s68, s67, 256
    buffer_load_dwordx4 v6, s[44:47], s68 offen lds
    v_mfma_f32_16x16x32_bf16 v[80:83], v[212:215], v[136:139], v[80:83]
    v_mfma_f32_16x16x32_bf16 v[112:115], v[212:215], v[140:143], v[112:115]
    buffer_load_dwordx4 v7, s[44:47], s68 offen offset:1024 lds
    s_add_u32 s67, s67, 262144
    s_add_u32 s96, s96, 8192
    s_sub_u32 s7, s96, s72
    s_cmp_eq_u32 s7, 24576
    s_cselect_b32 s96, s72, s96
    v_mfma_f32_16x16x32_bf16 v[84:87], v[216:219], v[136:139], v[84:87]
    v_mfma_f32_16x16x32_bf16 v[116:119], v[216:219], v[140:143], v[116:119]
    v_mfma_f32_16x16x32_bf16 v[88:91], v[220:223], v[136:139], v[88:91]
    v_mfma_f32_16x16x32_bf16 v[120:123], v[220:223], v[140:143], v[120:123]
    v_mfma_f32_16x16x32_bf16 v[92:95], v[224:227], v[136:139], v[92:95]
    v_mfma_f32_16x16x32_bf16 v[124:127], v[224:227], v[140:143], v[124:127]
    v_mfma_f32_16x16x32_bf16 v[128:131], v[184:187], v[144:147], v[128:131]
    v_mfma_f32_16x16x32_bf16 v[132:135], v[188:191], v[144:147], v[132:135]
    s_waitcnt lgkmcnt(0)
    s_waitcnt vmcnt(4)
    s_barrier
    v_add_u32 v247, s74, v11
    v_add_u32 v246, s61, v247
    v_add_u32 v228, s75, v10
    v_xor_b32 v229, 32, v228
    v_xor_b32 v230, 64, v228
    v_xor_b32 v231, 96, v228
    v_xor_b32 v232, 128, v228
    v_xor_b32 v233, 160, v228
    v_xor_b32 v234, 192, v228
    v_xor_b32 v235, 224, v228
    s_lshl_b32 s7, s60, 6
    v_xor_b32 v244, s7, v228
    v_xor_b32 v245, 32, v244
    s_add_u32 s75, s75, 8192
    s_sub_u32 s7, s75, s72
    s_cmp_eq_u32 s7, 24576
    s_cselect_b32 s75, s72, s75
    ds_read_b128 v[136:139], v246 offset:0
    ds_read_b128 v[140:143], v246 offset:2048
    ds_read_b128 v[144:147], v247 offset:16384
    ds_read_b64_tr_b16 v[196:197], v228 offset:0
    ds_read_b64_tr_b16 v[198:199], v228 offset:1024
    ds_read_b64_tr_b16 v[200:201], v229 offset:0
    ds_read_b64_tr_b16 v[202:203], v229 offset:1024
    ds_read_b64_tr_b16 v[204:205], v230 offset:0
    ds_read_b64_tr_b16 v[206:207], v230 offset:1024
    ds_read_b64_tr_b16 v[208:209], v231 offset:0
    ds_read_b64_tr_b16 v[210:211], v231 offset:1024
    ds_read_b64_tr_b16 v[212:213], v232 offset:0
    ds_read_b64_tr_b16 v[214:215], v232 offset:1024
    ds_read_b64_tr_b16 v[216:217], v233 offset:0
    ds_read_b64_tr_b16 v[218:219], v233 offset:1024
    ds_read_b64_tr_b16 v[220:221], v234 offset:0
    ds_read_b64_tr_b16 v[222:223], v234 offset:1024
    ds_read_b64_tr_b16 v[224:225], v235 offset:0
    ds_read_b64_tr_b16 v[226:227], v235 offset:1024
    ds_read_b64_tr_b16 v[184:185], v244 offset:0
    ds_read_b64_tr_b16 v[186:187], v244 offset:1024
    ds_read_b64_tr_b16 v[188:189], v245 offset:0
    ds_read_b64_tr_b16 v[190:191], v245 offset:1024
    v_mfma_f32_16x16x32_bf16 v[64:67], v[16:19], v[148:151], v[64:67]
    v_mfma_f32_16x16x32_bf16 v[96:99], v[16:19], v[152:155], v[96:99]
    v_mfma_f32_16x16x32_bf16 v[68:71], v[20:23], v[148:151], v[68:71]
    v_mfma_f32_16x16x32_bf16 v[100:103], v[20:23], v[152:155], v[100:103]
    s_add_u32 m0, s76, s96
    s_nop 0
    buffer_load_dwordx4 v6, s[44:47], s67 offen lds
    v_mfma_f32_16x16x32_bf16 v[72:75], v[24:27], v[148:151], v[72:75]
    v_mfma_f32_16x16x32_bf16 v[104:107], v[24:27], v[152:155], v[104:107]
    buffer_load_dwordx4 v7, s[44:47], s67 offen offset:1024 lds
    v_mfma_f32_16x16x32_bf16 v[76:79], v[28:31], v[148:151], v[76:79]
    v_mfma_f32_16x16x32_bf16 v[108:111], v[28:31], v[152:155], v[108:111]
    s_add_u32 m0, m0, 81920
    s_add_u32 s68, s67, 256
    buffer_load_dwordx4 v6, s[44:47], s68 offen lds
    v_mfma_f32_16x16x32_bf16 v[80:83], v[32:35], v[148:151], v[80:83]
    v_mfma_f32_16x16x32_bf16 v[112:115], v[32:35], v[152:155], v[112:115]
    buffer_load_dwordx4 v7, s[44:47], s68 offen offset:1024 lds
    s_add_u32 s67, s67, 262144
    s_add_u32 s96, s96, 8192
    s_sub_u32 s7, s96, s72
    s_cmp_eq_u32 s7, 24576
    s_cselect_b32 s96, s72, s96
    v_mfma_f32_16x16x32_bf16 v[84:87], v[36:39], v[148:151], v[84:87]
    v_mfma_f32_16x16x32_bf16 v[116:119], v[36:39], v[152:155], v[116:119]
    v_mfma_f32_16x16x32_bf16 v[88:91], v[40:43], v[148:151], v[88:91]
    v_mfma_f32_16x16x32_bf16 v[120:123], v[40:43], v[152:155], v[120:123]
    v_mfma_f32_16x16x32_bf16 v[92:95], v[44:47], v[148:151], v[92:95]
    v_mfma_f32_16x16x32_bf16 v[124:127], v[44:47], v[152:155], v[124:127]
    v_mfma_f32_16x16x32_bf16 v[128:131], v[48:51], v[156:159], v[128:131]
    v_mfma_f32_16x16x32_bf16 v[132:135], v[52:55], v[156:159], v[132:135]
    s_sub_u32 s63, s63, 1
    s_cmp_lg_u32 s63, 0
    s_nop 5
    s_cbranch_scc1 L_k1_qA
    s_waitcnt vmcnt(0)
    s_waitcnt lgkmcnt(0)
    s_branch L_k1_qdone
L_k1_roleBC:
    s_cmp_eq_u32 s73, 7
    s_cbranch_scc1 L_k1_roleC
    s_sub_u32 s7, s73, 4
    s_mul_i32 s7, s7, 6
    s_mul_i32 s64, s7, 10240
    s_lshl_b32 s93, s7, 10
    s_and_b32 s7, s73, 1
    s_lshl_b32 s7, s7, 6
    v_xor_b32 v5, s7, v5
    v_xor_b32 v6, 64, v5
    s_add_u32 s7, s74, s93
    s_add_u32 m0, s7, 0
    s_add_u32 s68, s64, s92
    buffer_load_dwordx4 v5, s[40:43], s68 offen lds
    s_add_u32 s7, s74, s93
    s_add_u32 m0, s7, 1024
    s_add_u32 s68, s64, s92
    s_add_u32 s68, s68, 10240
    buffer_load_dwordx4 v6, s[40:43], s68 offen lds
    s_add_u32 s7, s74, s93
    s_add_u32 m0, s7, 2048
    s_add_u32 s68, s64, s92
    s_add_u32 s68, s68, 20480
    buffer_load_dwordx4 v5, s[40:43], s68 offen lds
    s_add_u32 s7, s74, s93
    s_add_u32 m0, s7, 3072
    s_add_u32 s68, s64, s92
    s_add_u32 s68, s68, 30720
    buffer_load_dwordx4 v6, s[40:43], s68 offen lds
    s_add_u32 s7, s74, s93
    s_add_u32 m0, s7, 4096
    s_add_u32 s68, s64, s92
    s_add_u32 s68, s68, 40960
    buffer_load_dwordx4 v5, s[40:43], s68 offen lds
    s_add_u32 s7, s74, s93
    s_add_u32 m0, s7, 5120
    s_add_u32 s68, s64, s92
    s_add_u32 s68, s68, 51200
    buffer_load_dwordx4 v6, s[40:43], s68 offen lds
    s_add_u32 s92, s92, 128
    s_waitcnt vmcnt(0)
    s_barrier
    s_mov_b32 s94, s39
    v_add_u32 v247, s74, v11
    v_add_u32 v246, s61, v247
    v_add_u32 v228, s75, v10
    v_xor_b32 v229, 32, v228
    v_xor_b32 v230, 64, v228
    v_xor_b32 v231, 96, v228
    v_xor_b32 v232, 128, v228
    v_xor_b32 v233, 160, v228
    v_xor_b32 v234, 192, v228
    v_xor_b32 v235, 224, v228
    s_lshl_b32 s7, s60, 6
    v_xor_b32 v244, s7, v228
    v_xor_b32 v245, 32, v244
    s_add_u32 s75, s75, 8192
    s_sub_u32 s7, s75, s72
    s_cmp_eq_u32 s7, 24576
    s_cselect_b32 s75, s72, s75
    ds_read_b128 v[136:139], v246 offset:0
    ds_read_b128 v[140:143], v246 offset:2048
    ds_read_b128 v[144:147], v247 offset:16384
    ds_read_b64_tr_b16 v[196:197], v228 offset:0
    ds_read_b64_tr_b16 v[198:199], v228 offset:1024
    ds_read_b64_tr_b16 v[200:201], v229 offset:0
    ds_read_b64_tr_b16 v[202:203], v229 offset:1024
    ds_read_b64_tr_b16 v[204:205], v230 offset:0
    ds_read_b64_tr_b16 v[206:207], v230 offset:1024
    ds_read_b64_tr_b16 v[208:209], v231 offset:0
    ds_read_b64_tr_b16 v[210:211], v231 offset:1024
    ds_read_b64_tr_b16 v[212:213], v232 offset:0
    ds_read_b64_tr_b16 v[214:215], v232 offset:1024
    ds_read_b64_tr_b16 v[216:217], v233 offset:0
    ds_read_b64_tr_b16 v[218:219], v233 offset:1024
    ds_read_b64_tr_b16 v[220:221], v234 offset:0
    ds_read_b64_tr_b16 v[222:223], v234 offset:1024
    ds_read_b64_tr_b16 v[224:225], v235 offset:0
    ds_read_b64_tr_b16 v[226:227], v235 offset:1024
    ds_read_b64_tr_b16 v[184:185], v244 offset:0
    ds_read_b64_tr_b16 v[186:187], v244 offset:1024
    ds_read_b64_tr_b16 v[188:189], v245 offset:0
    ds_read_b64_tr_b16 v[190:191], v245 offset:1024
    s_add_u32 s7, s94, s93
    s_add_u32 m0, s7, 0
    s_add_u32 s68, s64, s92
    buffer_load_dwordx4 v5, s[40:43], s68 offen lds
    s_add_u32 s7, s94, s93
    s_add_u32 m0, s7, 1024
    s_add_u32 s68, s64, s92
    s_add_u32 s68, s68, 10240
    buffer_load_dwordx4 v6, s[40:43], s68 offen lds
    s_add_u32 s7, s94, s93
    s_add_u32 m0, s7, 2048
    s_add_u32 s68, s64, s92
    s_add_u32 s68, s68, 20480
    buffer_load_dwordx4 v5, s[40:43], s68 offen lds
    s_add_u32 s7, s94, s93
    s_add_u32 m0, s7, 3072
    s_add_u32 s68, s64, s92
    s_add_u32 s68, s68, 30720
    buffer_load_dwordx4 v6, s[40:43], s68 offen lds
    s_add_u32 s7, s94, s93
    s_add_u32 m0, s7, 4096
    s_add_u32 s68, s64, s92
    s_add_u32 s68, s68, 40960
    buffer_load_dwordx4 v5, s[40:43], s68 offen lds
    s_add_u32 s7, s94, s93
    s_add_u32 m0, s7, 5120
    s_add_u32 s68, s64, s92
    s_add_u32 s68, s68, 51200
    buffer_load_dwordx4 v6, s[40:43], s68 offen lds
    s_add_u32 s92, s92, 128
    s_nop 7
L_k1_qB:
    s_waitcnt lgkmcnt(0)
    s_barrier
    v_xor_b32 v246, 64, v246
    v_xor_b32 v247, 64, v247
    v_add_u32 v228, s75, v10
    v_xor_b32 v229, 32, v228
    v_xor_b32 v230, 64, v228
    v_xor_b32 v231, 96, v228
    v_xor_b32 v232, 128, v228
    v_xor_b32 v233, 160, v228
    v_xor_b32 v234, 192, v228
    v_xor_b32 v235, 224, v228
    s_lshl_b32 s7, s60, 6
    v_xor_b32 v244, s7, v228
    v_xor_b32 v245, 32, v244
    s_add_u32 s75, s75, 8192
    s_sub_u32 s7, s75, s72
    s_cmp_eq_u32 s7, 24576
    s_cselect_b32 s75, s72, s75
    ds_read_b128 v[148:151], v246 offset:0
    ds_read_b128 v[152:155], v246 offset:2048
    ds_read_b128 v[156:159], v247 offset:16384
    ds_read_b64_tr_b16 v[16:17], v228 offset:0
    ds_read_b64_tr_b16 v[18:19], v228 offset:1024
    ds_read_b64_tr_b16 v[20:21], v229 offset:0
    ds_read_b64_tr_b16 v[22:23], v229 offset:1024
    ds_read_b64_tr_b16 v[24:25], v230 offset:0
    ds_read_b64_tr_b16 v[26:27], v230 offset:1024
    ds_read_b64_tr_b16 v[28:29], v231 offset:0
    ds_read_b64_tr_b16 v[30:31], v231 offset:1024
    ds_read_b64_tr_b16 v[32:33], v232 offset:0
    ds_read_b64_tr_b16 v[34:35], v232 offset:1024
    ds_read_b64_tr_b16 v[36:37], v233 offset:0
    ds_read_b64_tr_b16 v[38:39], v233 offset:1024
    ds_read_b64_tr_b16 v[40:41], v234 offset:0
    ds_read_b64_tr_b16 v[42:43], v234 offset:1024
    ds_read_b64_tr_b16 v[44:45], v235 offset:0
    ds_read_b64_tr_b16 v[46:47], v235 offset:1024
    ds_read_b64_tr_b16 v[48:49], v244 offset:0
    ds_read_b64_tr_b16 v[50:51], v244 offset:1024
    ds_read_b64_tr_b16 v[52:53], v245 offset:0
    ds_read_b64_tr_b16 v[54:55], v245 offset:1024
    s_mov_b32 s7, s74
    s_mov_b32 s74, s39
    s_mov_b32 s39, s7
    v_mfma_f32_16x16x32_bf16 v[64:67], v[196:199], v[136:139], v[64:67]
    v_mfma_f32_16x16x32_bf16 v[96:99], v[196:199], v[140:143], v[96:99]
    v_mfma_f32_16x16x32_bf16 v[68:71], v[200:203], v[136:139], v[68:71]
    v_mfma_f32_16x16x32_bf16 v[100:103], v[200:203], v[140:143], v[100:103]
    v_mfma_f32_16x16x32_bf16 v[72:75], v[204:207], v[136:139], v[72:75]
    v_mfma_f32_16x16x32_bf16 v[104:107], v[204:207], v[140:143], v[104:107]
    v_mfma_f32_16x16x32_bf16 v[76:79], v[208:211], v[136:139], v[76:79]
    v_mfma_f32_16x16x32_bf16 v[108:111], v[208:211], v[140:143], v[108:111]
    v_mfma_f32_16x16x32_bf16 v[80:83], v[212:215], v[136:139], v[80:83]
    v_mfma_f32_16x16x32_bf16 v[112:115], v[212:215], v[140:143], v[112:115]
    v_mfma_f32_16x16x32_bf16 v[84:87], v[216:219], v[136:139], v[84:87]
    v_mfma_f32_16x16x32_bf16 v[116:119], v[216:219], v[140:143], v[116:119]
    v_mfma_f32_16x16x32_bf16 v[88:91], v[220:223], v[136:139], v[88:91]
    v_mfma_f32_16x16x32_bf16 v[120:123], v[220:223], v[140:143], v[120:123]
    v_mfma_f32_16x16x32_bf16 v[92:95], v[224:227], v[136:139], v[92:95]
    v_mfma_f32_16x16x32_bf16 v[124:127], v[224:227], v[140:143], v[124:127]
    v_mfma_f32_16x16x32_bf16 v[128:131], v[184:187], v[144:147], v[128:131]
    v_mfma_f32_16x16x32_bf16 v[132:135], v[188:191], v[144:147], v[132:135]
    s_waitcnt lgkmcnt(0)
    s_waitcnt vmcnt(0)
    s_barrier
    s_mov_b32 s94, s39
    v_add_u32 v247, s74, v11
    v_add_u32 v246, s61, v247
    v_add_u32 v228, s75, v10
    v_xor_b32 v229, 32, v228
    v_xor_b32 v230, 64, v228
    v_xor_b32 v231, 96, v228
    v_xor_b32 v232, 128, v228
    v_xor_b32 v233, 160, v228
    v_xor_b32 v234, 192, v228
    v_xor_b32 v235, 224, v228
    s_lshl_b32 s7, s60, 6
    v_xor_b32 v244, s7, v228
    v_xor_b32 v245, 32, v244
    s_add_u32 s75, s75, 8192
    s_sub_u32 s7, s75, s72
    s_cmp_eq_u32 s7, 24576
    s_cselect_b32 s75, s72, s75
    ds_read_b128 v[136:139], v246 offset:0
    ds_read_b128 v[140:143], v246 offset:2048
    ds_read_b128 v[144:147], v247 offset:16384
    ds_read_b64_tr_b16 v[196:197], v228 offset:0
    ds_read_b64_tr_b16 v[198:199], v228 offset:1024
    ds_read_b64_tr_b16 v[200:201], v229 offset:0
    ds_read_b64_tr_b16 v[202:203], v229 offset:1024
    ds_read_b64_tr_b16 v[204:205], v230 offset:0
    ds_read_b64_tr_b16 v[206:207], v230 offset:1024
    ds_read_b64_tr_b16 v[208:209], v231 offset:0
    ds_read_b64_tr_b16 v[210:211], v231 offset:1024
    ds_read_b64_tr_b16 v[212:213], v232 offset:0
    ds_read_b64_tr_b16 v[214:215], v232 offset:1024
    ds_read_b64_tr_b16 v[216:217], v233 offset:0
    ds_read_b64_tr_b16 v[218:219], v233 offset:1024
    ds_read_b64_tr_b16 v[220:221], v234 offset:0
    ds_read_b64_tr_b16 v[222:223], v234 offset:1024
    ds_read_b64_tr_b16 v[224:225], v235 offset:0
    ds_read_b64_tr_b16 v[226:227], v235 offset:1024
    ds_read_b64_tr_b16 v[184:185], v244 offset:0
    ds_read_b64_tr_b16 v[186:187], v244 offset:1024
    ds_read_b64_tr_b16 v[188:189], v245 offset:0
    ds_read_b64_tr_b16 v[190:191], v245 offset:1024
    v_mfma_f32_16x16x32_bf16 v[64:67], v[16:19], v[148:151], v[64:67]
    v_mfma_f32_16x16x32_bf16 v[96:99], v[16:19], v[152:155], v[96:99]
    v_mfma_f32_16x16x32_bf16 v[68:71], v[20:23], v[148:151], v[68:71]
    v_mfma_f32_16x16x32_bf16 v[100:103], v[20:23], v[152:155], v[100:103]
    s_add_u32 s7, s94, s93
    s_add_u32 m0, s7, 0
    s_add_u32 s68, s64, s92
    buffer_load_dwordx4 v5, s[40:43], s68 offen lds
    v_mfma_f32_16x16x32_bf16 v[72:75], v[24:27], v[148:151], v[72:75]
    v_mfma_f32_16x16x32_bf16 v[104:107], v[24:27], v[152:155], v[104:107]
    s_add_u32 s7, s94, s93
    s_add_u32 m0, s7, 1024
    s_add_u32 s68, s64, s92
    s_add_u32 s68, s68, 10240
    buffer_load_dwordx4 v6, s[40:43], s68 offen lds
    v_mfma_f32_16x16x32_bf16 v[76:79], v[28:31], v[148:151], v[76:79]
    v_mfma_f32_16x16x32_bf16 v[108:111], v[28:31], v[152:155], v[108:111]
    s_add_u32 s7, s94, s93
    s_add_u32 m0, s7, 2048
    s_add_u32 s68, s64, s92
    s_add_u32 s68, s68, 20480
    buffer_load_dwordx4 v5, s[40:43], s68 offen lds
    v_mfma_f32_16x16x32_bf16 v[80:83], v[32:35], v[148:151], v[80:83]
    v_mfma_f32_16x16x32_bf16 v[112:115], v[32:35], v[152:155], v[112:115]
    s_add_u32 s7, s94, s93
    s_add_u32 m0, s7, 3072
    s_add_u32 s68, s64, s92
    s_add_u32 s68, s68, 30720
    buffer_load_dwordx4 v6, s[40:43], s68 offen lds
    v_mfma_f32_16x16x32_bf16 v[84:87], v[36:39], v[148:151], v[84:87]
    v_mfma_f32_16x16x32_bf16 v[116:119], v[36:39], v[152:155], v[116:119]
    s_add_u32 s7, s94, s93
    s_add_u32 m0, s7, 4096
    s_add_u32 s68, s64, s92
    s_add_u32 s68, s68, 40960
    buffer_load_dwordx4 v5, s[40:43], s68 offen lds
    v_mfma_f32_16x16x32_bf16 v[88:91], v[40:43], v[148:151], v[88:91]
    v_mfma_f32_16x16x32_bf16 v[120:123], v[40:43], v[152:155], v[120:123]
    s_add_u32 s7, s94, s93
    s_add_u32 m0, s7, 5120
    s_add_u32 s68, s64, s92
    s_add_u32 s68, s68, 51200
    buffer_load_dwordx4 v6, s[40:43], s68 offen lds
    s_add_u32 s92, s92, 128
    v_mfma_f32_16x16x32_bf16 v[92:95], v[44:47], v[148:151], v[92:95]
    v_mfma_f32_16x16x32_bf16 v[124:127], v[44:47], v[152:155], v[124:127]
    v_mfma_f32_16x16x32_bf16 v[128:131], v[48:51], v[156:159], v[128:131]
    v_mfma_f32_16x16x32_bf16 v[132:135], v[52:55], v[156:159], v[132:135]
    s_sub_u32 s63, s63, 1
    s_cmp_lg_u32 s63, 0
    s_nop 5
    s_cbranch_scc1 L_k1_qB
    s_waitcnt vmcnt(0)
    s_waitcnt lgkmcnt(0)
    s_branch L_k1_qdone
L_k1_roleC:
    s_sub_u32 s16, s48, 131072
    s_subb_u32 s17, s49, 0
    s_and_b32 s17, s17, 0xffff
    s_mov_b32 s18, 131072
    s_mov_b32 s19, 0x20000
    s_sub_u32 s20, s52, 131072
    s_subb_u32 s21, s53, 0
    s_and_b32 s21, s21, 0xffff
    s_mov_b32 s22, 131072
    s_mov_b32 s23, 0x20000
    s_sub_u32 s24, s44, 256
    s_subb_u32 s25, s45, 0
    s_and_b32 s25, s25, 0xffff
    s_add_u32 s26, s46, 256
    s_mov_b32 s27, 0x20000
    v_subrev_u32 v6, s61, v4
    s_and_b32 s7, s38, 3
    s_lshl_b32 s7, s7, 4
    v_lshrrev_b32 v13, 2, v1
    v_add_u32 v13, s7, v13
    v_lshlrev_b32 v13, 13, v13
    v_and_b32 v14, 3, v1
    v_lshlrev_b32 v14, 7, v14
    v_add_u32 v13, v13, v14
    v_mov_b32 v15, 0x7ffffff0
    v_mov_b32 v7, v13
    s_lshr_b32 s7, s38, 2
    s_mul_i32 s7, s7, 18
    v_add_u32 v13, s7, v1
    v_mul_u32_u24 v13, 1280, v13
    v_cmp_gt_u32 vcc, 18, v1
    s_nop 1
    v_cndmask_b32 v5, v15, v13, vcc
    s_barrier
    v_add_u32 v247, s74, v11
    v_add_u32 v246, s61, v247
    v_add_u32 v228, s75, v10
    v_xor_b32 v229, 32, v228
    v_xor_b32 v230, 64, v228
    v_xor_b32 v231, 96, v228
    v_xor_b32 v232, 128, v228
    v_xor_b32 v233, 160, v228
    v_xor_b32 v234, 192, v228
    v_xor_b32 v235, 224, v228
    s_lshl_b32 s7, s60, 6
    v_xor_b32 v244, s7, v228
    v_xor_b32 v245, 32, v244
    s_add_u32 s75, s75, 8192
    s_sub_u32 s7, s75, s72
    s_cmp_eq_u32 s7, 24576
    s_cselect_b32 s75, s72, s75
    ds_read_b128 v[136:139], v246 offset:0
    ds_read_b128 v[140:143], v246 offset:2048
    ds_read_b128 v[144:147], v247 offset:16384
    ds_read_b64_tr_b16 v[196:197], v228 offset:0
    ds_read_b64_tr_b16 v[198:199], v228 offset:1024
    ds_read_b64_tr_b16 v[200:201], v229 offset:0
    ds_read_b64_tr_b16 v[202:203], v229 offset:1024
    ds_read_b64_tr_b16 v[204:205], v230 offset:0
    ds_read_b64_tr_b16 v[206:207], v230 offset:1024
    ds_read_b64_tr_b16 v[208:209], v231 offset:0
    ds_read_b64_tr_b16 v[210:211], v231 offset:1024
    ds_read_b64_tr_b16 v[212:213], v232 offset:0
    ds_read_b64_tr_b16 v[214:215], v232 offset:1024
    ds_read_b64_tr_b16 v[216:217], v233 offset:0
    ds_read_b64_tr_b16 v[218:219], v233 offset:1024
    ds_read_b64_tr_b16 v[220:221], v234 offset:0
    ds_read_b64_tr_b16 v[222:223], v234 offset:1024
    ds_read_b64_tr_b16 v[224:225], v235 offset:0
    ds_read_b64_tr_b16 v[226:227], v235 offset:1024
    ds_read_b64_tr_b16 v[184:185], v244 offset:0
    ds_read_b64_tr_b16 v[186:187], v244 offset:1024
    ds_read_b64_tr_b16 v[188:189], v245 offset:0
    ds_read_b64_tr_b16 v[190:191], v245 offset:1024
    s_waitcnt lgkmcnt(0)
    s_barrier
    v_xor_b32 v246, 64, v246
    v_xor_b32 v247, 64, v247
    v_add_u32 v228, s75, v10
    v_xor_b32 v229, 32, v228
    v_xor_b32 v230, 64, v228
    v_xor_b32 v231, 96, v228
    v_xor_b32 v232, 128, v228
    v_xor_b32 v233, 160, v228
    v_xor_b32 v234, 192, v228
    v_xor_b32 v235, 224, v228
    s_lshl_b32 s7, s60, 6
    v_xor_b32 v244, s7, v228
    v_xor_b32 v245, 32, v244
    s_add_u32 s75, s75, 8192
    s_sub_u32 s7, s75, s72
    s_cmp_eq_u32 s7, 24576
    s_cselect_b32 s75, s72, s75
    ds_read_b128 v[148:151], v246 offset:0
    ds_read_b128 v[152:155], v246 offset:2048
    ds_read_b128 v[156:159], v247 offset:16384
    ds_read_b64_tr_b16 v[16:17], v228 offset:0
    ds_read_b64_tr_b16 v[18:19], v228 offset:1024
    ds_read_b64_tr_b16 v[20:21], v229 offset:0
    ds_read_b64_tr_b16 v[22:23], v229 offset:1024
    ds_read_b64_tr_b16 v[24:25], v230 offset:0
    ds_read_b64_tr_b16 v[26:27], v230 offset:1024
    ds_read_b64_tr_b16 v[28:29], v231 offset:0
    ds_read_b64_tr_b16 v[30:31], v231 offset:1024
    ds_read_b64_tr_b16 v[32:33], v232 offset:0
    ds_read_b64_tr_b16 v[34:35], v232 offset:1024
    ds_read_b64_tr_b16 v[36:37], v233 offset:0
    ds_read_b64_tr_b16 v[38:39], v233 offset:1024
    ds_read_b64_tr_b16 v[40:41], v234 offset:0
    ds_read_b64_tr_b16 v[42:43], v234 offset:1024
    ds_read_b64_tr_b16 v[44:45], v235 offset:0
    ds_read_b64_tr_b16 v[46:47], v235 offset:1024
    ds_read_b64_tr_b16 v[48:49], v244 offset:0
    ds_read_b64_tr_b16 v[50:51], v244 offset:1024
    ds_read_b64_tr_b16 v[52:53], v245 offset:0
    ds_read_b64_tr_b16 v[54:55], v245 offset:1024
    s_mov_b32 s7, s74
    s_mov_b32 s74, s39
    s_mov_b32 s39, s7
    v_mfma_f32_16x16x32_bf16 v[64:67], v[196:199], v[136:139], v[64:67]
    v_mfma_f32_16x16x32_bf16 v[96:99], v[196:199], v[140:143], v[96:99]
    v_mfma_f32_16x16x32_bf16 v[68:71], v[200:203], v[136:139], v[68:71]
    v_mfma_f32_16x16x32_bf16 v[100:103], v[200:203], v[140:143], v[100:103]
    s_mov_b32 m0, 49152
    s_mov_b32 s68, 0
    buffer_load_dwordx4 v6, s[16:19], s68 offen offset:0 nt lds
    v_xor_b32 v13, 128, v6
    buffer_load_dwordx4 v13, s[16:19], s68 offen offset:1024 nt lds
    v_xor_b32 v13, 16, v6
    buffer_load_dwordx4 v13, s[16:19], s68 offen offset:2048 nt lds
    v_xor_b32 v13, 144, v6
    buffer_load_dwordx4 v13, s[16:19], s68 offen offset:3072 nt lds
    v_mfma_f32_16x16x32_bf16 v[72:75], v[204:207], v[136:139], v[72:75]
    v_mfma_f32_16x16x32_bf16 v[104:107], v[204:207], v[140:143], v[104:107]
    v_mfma_f32_16x16x32_bf16 v[76:79], v[208:211], v[136:139], v[76:79]
    v_mfma_f32_16x16x32_bf16 v[108:111], v[208:211], v[140:143], v[108:111]
    v_mfma_f32_16x16x32_bf16 v[80:83], v[212:215], v[136:139], v[80:83]
    v_mfma_f32_16x16x32_bf16 v[112:115], v[212:215], v[140:143], v[112:115]
    v_mfma_f32_16x16x32_bf16 v[84:87], v[216:219], v[136:139], v[84:87]
    v_mfma_f32_16x16x32_bf16 v[116:119], v[216:219], v[140:143], v[116:119]
    v_mfma_f32_16x16x32_bf16 v[88:91], v[220:223], v[136:139], v[88:91]
    v_mfma_f32_16x16x32_bf16 v[120:123], v[220:223], v[140:143], v[120:123]
    v_mfma_f32_16x16x32_bf16 v[92:95], v[224:227], v[136:139], v[92:95]
    v_mfma_f32_16x16x32_bf16 v[124:127], v[224:227], v[140:143], v[124:127]
    v_mfma_f32_16x16x32_bf16 v[128:131], v[184:187], v[144:147], v[128:131]
    v_mfma_f32_16x16x32_bf16 v[132:135], v[188:191], v[144:147], v[132:135]
    s_waitcnt lgkmcnt(0)
    s_barrier
    v_add_u32 v247, s74, v11
    v_add_u32 v246, s61, v247
    v_add_u32 v228, s75, v10
    v_xor_b32 v229, 32, v228
    v_xor_b32 v230, 64, v228
    v_xor_b32 v231, 96, v228
    v_xor_b32 v232, 128, v228
    v_xor_b32 v233, 160, v228
    v_xor_b32 v234, 192, v228
    v_xor_b32 v235, 224, v228
    s_lshl_b32 s7, s60, 6
    v_xor_b32 v244, s7, v228
    v_xor_b32 v245, 32, v244
    s_add_u32 s75, s75, 8192
    s_sub_u32 s7, s75, s72
    s_cmp_eq_u32 s7, 24576
    s_cselect_b32 s75, s72, s75
    ds_read_b128 v[136:139], v246 offset:0
    ds_read_b128 v[140:143], v246 offset:2048
    ds_read_b128 v[144:147], v247 offset:16384
    ds_read_b64_tr_b16 v[196:197], v228 offset:0
    ds_read_b64_tr_b16 v[198:199], v228 offset:1024
    ds_read_b64_tr_b16 v[200:201], v229 offset:0
    ds_read_b64_tr_b16 v[202:203], v229 offset:1024
    ds_read_b64_tr_b16 v[204:205], v230 offset:0
    ds_read_b64_tr_b16 v[206:207], v230 offset:1024
    ds_read_b64_tr_b16 v[208:209], v231 offset:0
    ds_read_b64_tr_b16 v[210:211], v231 offset:1024
    ds_read_b64_tr_b16 v[212:213], v232 offset:0
    ds_read_b64_tr_b16 v[214:215], v232 offset:1024
    ds_read_b64_tr_b16 v[216:217], v233 offset:0
    ds_read_b64_tr_b16 v[218:219], v233 offset:1024
    ds_read_b64_tr_b16 v[220:221], v234 offset:0
    ds_read_b64_tr_b16 v[222:223], v234 offset:1024
    ds_read_b64_tr_b16 v[224:225], v235 offset:0
    ds_read_b64_tr_b16 v[226:227], v235 offset:1024
    ds_read_b64_tr_b16 v[184:185], v244 offset:0
    ds_read_b64_tr_b16 v[186:187], v244 offset:1024
    ds_read_b64_tr_b16 v[188:189], v245 offset:0
    ds_read_b64_tr_b16 v[190:191], v245 offset:1024
    v_mfma_f32_16x16x32_bf16 v[64:67], v[16:19], v[148:151], v[64:67]
    v_mfma_f32_16x16x32_bf16 v[96:99], v[16:19], v[152:155], v[96:99]
    v_mfma_f32_16x16x32_bf16 v[68:71], v[20:23], v[148:151], v[68:71]
    v_mfma_f32_16x16x32_bf16 v[100:103], v[20:23], v[152:155], v[100:103]
    s_mov_b32 m0, 53248
    s_mov_b32 s68, 4096
    buffer_load_dwordx4 v6, s[16:19], s68 offen offset:0 nt lds
    v_xor_b32 v13, 128, v6
    buffer_load_dwordx4 v13, s[16:19], s68 offen offset:1024 nt lds
    v_xor_b32 v13, 16, v6
    buffer_load_dwordx4 v13, s[16:19], s68 offen offset:2048 nt lds
    v_xor_b32 v13, 144, v6
    buffer_load_dwordx4 v13, s[16:19], s68 offen offset:3072 nt lds
    v_mfma_f32_16x16x32_bf16 v[72:75], v[24:27], v[148:151], v[72:75]
    v_mfma_f32_16x16x32_bf16 v[104:107], v[24:27], v[152:155], v[104:107]
    v_mfma_f32_16x16x32_bf16 v[76:79], v[28:31], v[148:151], v[76:79]
    v_mfma_f32_16x16x32_bf16 v[108:111], v[28:31], v[152:155], v[108:111]
    v_mfma_f32_16x16x32_bf16 v[80:83], v[32:35], v[148:151], v[80:83]
    v_mfma_f32_16x16x32_bf16 v[112:115], v[32:35], v[152:155], v[112:115]
    v_mfma_f32_16x16x32_bf16 v[84:87], v[36:39], v[148:151], v[84:87]
    v_mfma_f32_16x16x32_bf16 v[116:119], v[36:39], v[152:155], v[116:119]
    v_mfma_f32_16x16x32_bf16 v[88:91], v[40:43], v[148:151], v[88:91]
    v_mfma_f32_16x16x32_bf16 v[120:123], v[40:43], v[152:155], v[120:123]
    v_mfma_f32_16x16x32_bf16 v[92:95], v[44:47], v[148:151], v[92:95]
    v_mfma_f32_16x16x32_bf16 v[124:127], v[44:47], v[152:155], v[124:127]
    v_mfma_f32_16x16x32_bf16 v[128:131], v[48:51], v[156:159], v[128:131]
    v_mfma_f32_16x16x32_bf16 v[132:135], v[52:55], v[156:159], v[132:135]
    s_waitcnt lgkmcnt(0)
    s_barrier
    v_xor_b32 v246, 64, v246
    v_xor_b32 v247, 64, v247
    v_add_u32 v228, s75, v10
    v_xor_b32 v229, 32, v228
    v_xor_b32 v230, 64, v228
    v_xor_b32 v231, 96, v228
    v_xor_b32 v232, 128, v228
    v_xor_b32 v233, 160, v228
    v_xor_b32 v234, 192, v228
    v_xor_b32 v235, 224, v228
    s_lshl_b32 s7, s60, 6
    v_xor_b32 v244, s7, v228
    v_xor_b32 v245, 32, v244
    s_add_u32 s75, s75, 8192
    s_sub_u32 s7, s75, s72
    s_cmp_eq_u32 s7, 24576
    s_cselect_b32 s75, s72, s75
    ds_read_b128 v[148:151], v246 offset:0
    ds_read_b128 v[152:155], v246 offset:2048
    ds_read_b128 v[156:159], v247 offset:16384
    ds_read_b64_tr_b16 v[16:17], v228 offset:0
    ds_read_b64_tr_b16 v[18:19], v228 offset:1024
    ds_read_b64_tr_b16 v[20:21], v229 offset:0
    ds_read_b64_tr_b16 v[22:23], v229 offset:1024
    ds_read_b64_tr_b16 v[24:25], v230 offset:0
    ds_read_b64_tr_b16 v[26:27], v230 offset:1024
    ds_read_b64_tr_b16 v[28:29], v231 offset:0
    ds_read_b64_tr_b16 v[30:31], v231 offset:1024
    ds_read_b64_tr_b16 v[32:33], v232 offset:0
    ds_read_b64_tr_b16 v[34:35], v232 offset:1024
    ds_read_b64_tr_b16 v[36:37], v233 offset:0
    ds_read_b64_tr_b16 v[38:39], v233 offset:1024
    ds_read_b64_tr_b16 v[40:41], v234 offset:0
    ds_read_b64_tr_b16 v[42:43], v234 offset:1024
    ds_read_b64_tr_b16 v[44:45], v235 offset:0
    ds_read_b64_tr_b16 v[46:47], v235 offset:1024
    ds_read_b64_tr_b16 v[48:49], v244 offset:0
    ds_read_b64_tr_b16 v[50:51], v244 offset:1024
    ds_read_b64_tr_b16 v[52:53], v245 offset:0
    ds_read_b64_tr_b16 v[54:55], v245 offset:1024
    s_mov_b32 s7, s74
    s_mov_b32 s74, s39
    s_mov_b32 s39, s7
    v_mfma_f32_16x16x32_bf16 v[64:67], v[196:199], v[136:139], v[64:67]
    v_mfma_f32_16x16x32_bf16 v[96:99], v[196:199], v[140:143], v[96:99]
    v_mfma_f32_16x16x32_bf16 v[68:71], v[200:203], v[136:139], v[68:71]
    v_mfma_f32_16x16x32_bf16 v[100:103], v[200:203], v[140:143], v[100:103]
    s_mov_b32 m0, 57344
    s_mov_b32 s68, 8192
    buffer_load_dwordx4 v6, s[16:19], s68 offen offset:0 nt lds
    v_xor_b32 v13, 128, v6
    buffer_load_dwordx4 v13, s[16:19], s68 offen offset:1024 nt lds
    v_xor_b32 v13, 16, v6
    buffer_load_dwordx4 v13, s[16:19], s68 offen offset:2048 nt lds
    v_xor_b32 v13, 144, v6
    buffer_load_dwordx4 v13, s[16:19], s68 offen offset:3072 nt lds
    v_mfma_f32_16x16x32_bf16 v[72:75], v[204:207], v[136:139], v[72:75]
    v_mfma_f32_16x16x32_bf16 v[104:107], v[204:207], v[140:143], v[104:107]
    v_mfma_f32_16x16x32_bf16 v[76:79], v[208:211], v[136:139], v[76:79]
    v_mfma_f32_16x16x32_bf16 v[108:111], v[208:211], v[140:143], v[108:111]
    v_mfma_f32_16x16x32_bf16 v[80:83], v[212:215], v[136:139], v[80:83]
    v_mfma_f32_16x16x32_bf16 v[112:115], v[212:215], v[140:143], v[112:115]
    v_mfma_f32_16x16x32_bf16 v[84:87], v[216:219], v[136:139], v[84:87]
    v_mfma_f32_16x16x32_bf16 v[116:119], v[216:219], v[140:143], v[116:119]
    v_mfma_f32_16x16x32_bf16 v[88:91], v[220:223], v[136:139], v[88:91]
    v_mfma_f32_16x16x32_bf16 v[120:123], v[220:223], v[140:143], v[120:123]
    v_mfma_f32_16x16x32_bf16 v[92:95], v[224:227], v[136:139], v[92:95]
    v_mfma_f32_16x16x32_bf16 v[124:127], v[224:227], v[140:143], v[124:127]
    v_mfma_f32_16x16x32_bf16 v[128:131], v[184:187], v[144:147], v[128:131]
    v_mfma_f32_16x16x32_bf16 v[132:135], v[188:191], v[144:147], v[132:135]
    s_waitcnt lgkmcnt(0)
    s_barrier
    v_add_u32 v247, s74, v11
    v_add_u32 v246, s61, v247
    v_add_u32 v228, s75, v10
    v_xor_b32 v229, 32, v228
    v_xor_b32 v230, 64, v228
    v_xor_b32 v231, 96, v228
    v_xor_b32 v232, 128, v228
    v_xor_b32 v233, 160, v228
    v_xor_b32 v234, 192, v228
    v_xor_b32 v235, 224, v228
    s_lshl_b32 s7, s60, 6
    v_xor_b32 v244, s7, v228
    v_xor_b32 v245, 32, v244
    s_add_u32 s75, s75, 8192
    s_sub_u32 s7, s75, s72
    s_cmp_eq_u32 s7, 24576
    s_cselect_b32 s75, s72, s75
    ds_read_b128 v[136:139], v246 offset:0
    ds_read_b128 v[140:143], v246 offset:2048
    ds_read_b128 v[144:147], v247 offset:16384
    ds_read_b64_tr_b16 v[196:197], v228 offset:0
    ds_read_b64_tr_b16 v[198:199], v228 offset:1024
    ds_read_b64_tr_b16 v[200:201], v229 offset:0
    ds_read_b64_tr_b16 v[202:203], v229 offset:1024
    ds_read_b64_tr_b16 v[204:205], v230 offset:0
    ds_read_b64_tr_b16 v[206:207], v230 offset:1024
    ds_read_b64_tr_b16 v[208:209], v231 offset:0
    ds_read_b64_tr_b16 v[210:211], v231 offset:1024
    ds_read_b64_tr_b16 v[212:213], v232 offset:0
    ds_read_b64_tr_b16 v[214:215], v232 offset:1024
    ds_read_b64_tr_b16 v[216:217], v233 offset:0
    ds_read_b64_tr_b16 v[218:219], v233 offset:1024
    ds_read_b64_tr_b16 v[220:221], v234 offset:0
    ds_read_b64_tr_b16 v[222:223], v234 offset:1024
    ds_read_b64_tr_b16 v[224:225], v235 offset:0
    ds_read_b64_tr_b16 v[226:227], v235 offset:1024
    ds_read_b64_tr_b16 v[184:185], v244 offset:0
    ds_read_b64_tr_b16 v[186:187], v244 offset:1024
    ds_read_b64_tr_b16 v[188:189], v245 offset:0
    ds_read_b64_tr_b16 v[190:191], v245 offset:1024
    v_mfma_f32_16x16x32_bf16 v[64:67], v[16:19], v[148:151], v[64:67]
    v_mfma_f32_16x16x32_bf16 v[96:99], v[16:19], v[152:155], v[96:99]
    v_mfma_f32_16x16x32_bf16 v[68:71], v[20:23], v[148:151], v[68:71]
    v_mfma_f32_16x16x32_bf16 v[100:103], v[20:23], v[152:155], v[100:103]
    s_mov_b32 m0, 61440
    s_mov_b32 s68, 12288
    buffer_load_dwordx4 v6, s[16:19], s68 offen offset:0 nt lds
    v_xor_b32 v13, 128, v6
    buffer_load_dwordx4 v13, s[16:19], s68 offen offset:1024 nt lds
    v_xor_b32 v13, 16, v6
    buffer_load_dwordx4 v13, s[16:19], s68 offen offset:2048 nt lds
    v_xor_b32 v13, 144, v6
    buffer_load_dwordx4 v13, s[16:19], s68 offen offset:3072 nt lds
    v_mfma_f32_16x16x32_bf16 v[72:75], v[24:27], v[148:151], v[72:75]
    v_mfma_f32_16x16x32_bf16 v[104:107], v[24:27], v[152:155], v[104:107]
    v_mfma_f32_16x16x32_bf16 v[76:79], v[28:31], v[148:151], v[76:79]
    v_mfma_f32_16x16x32_bf16 v[108:111], v[28:31], v[152:155], v[108:111]
    v_mfma_f32_16x16x32_bf16 v[80:83], v[32:35], v[148:151], v[80:83]
    v_mfma_f32_16x16x32_bf16 v[112:115], v[32:35], v[152:155], v[112:115]
    v_mfma_f32_16x16x32_bf16 v[84:87], v[36:39], v[148:151], v[84:87]
    v_mfma_f32_16x16x32_bf16 v[116:119], v[36:39], v[152:155], v[116:119]
    v_mfma_f32_16x16x32_bf16 v[88:91], v[40:43], v[148:151], v[88:91]
    v_mfma_f32_16x16x32_bf16 v[120:123], v[40:43], v[152:155], v[120:123]
    v_mfma_f32_16x16x32_bf16 v[92:95], v[44:47], v[148:151], v[92:95]
    v_mfma_f32_16x16x32_bf16 v[124:127], v[44:47], v[152:155], v[124:127]
    v_mfma_f32_16x16x32_bf16 v[128:131], v[48:51], v[156:159], v[128:131]
    v_mfma_f32_16x16x32_bf16 v[132:135], v[52:55], v[156:159], v[132:135]
    s_waitcnt lgkmcnt(0)
    s_barrier
    v_xor_b32 v246, 64, v246
    v_xor_b32 v247, 64, v247
    v_add_u32 v228, s75, v10
    v_xor_b32 v229, 32, v228
    v_xor_b32 v230, 64, v228
    v_xor_b32 v231, 96, v228
    v_xor_b32 v232, 128, v228
    v_xor_b32 v233, 160, v228
    v_xor_b32 v234, 192, v228
    v_xor_b32 v235, 224, v228
    s_lshl_b32 s7, s60, 6
    v_xor_b32 v244, s7, v228
    v_xor_b32 v245, 32, v244
    s_add_u32 s75, s75, 8192
    s_sub_u32 s7, s75, s72
    s_cmp_eq_u32 s7, 24576
    s_cselect_b32 s75, s72, s75
    ds_read_b128 v[148:151], v246 offset:0
    ds_read_b128 v[152:155], v246 offset:2048
    ds_read_b128 v[156:159], v247 offset:16384
    ds_read_b64_tr_b16 v[16:17], v228 offset:0
    ds_read_b64_tr_b16 v[18:19], v228 offset:1024
    ds_read_b64_tr_b16 v[20:21], v229 offset:0
    ds_read_b64_tr_b16 v[22:23], v229 offset:1024
    ds_read_b64_tr_b16 v[24:25], v230 offset:0
    ds_read_b64_tr_b16 v[26:27], v230 offset:1024
    ds_read_b64_tr_b16 v[28:29], v231 offset:0
    ds_read_b64_tr_b16 v[30:31], v231 offset:1024
    ds_read_b64_tr_b16 v[32:33], v232 offset:0
    ds_read_b64_tr_b16 v[34:35], v232 offset:1024
    ds_read_b64_tr_b16 v[36:37], v233 offset:0
    ds_read_b64_tr_b16 v[38:39], v233 offset:1024
    ds_read_b64_tr_b16 v[40:41], v234 offset:0
    ds_read_b64_tr_b16 v[42:43], v234 offset:1024
    ds_read_b64_tr_b16 v[44:45], v235 offset:0
    ds_read_b64_tr_b16 v[46:47], v235 offset:1024
    ds_read_b64_tr_b16 v[48:49], v244 offset:0
    ds_read_b64_tr_b16 v[50:51], v244 offset:1024
    ds_read_b64_tr_b16 v[52:53], v245 offset:0
    ds_read_b64_tr_b16 v[54:55], v245 offset:1024
    s_mov_b32 s7, s74
    s_mov_b32 s74, s39
    s_mov_b32 s39, s7
    v_mfma_f32_16x16x32_bf16 v[64:67], v[196:199], v[136:139], v[64:67]
    v_mfma_f32_16x16x32_bf16 v[96:99], v[196:199], v[140:143], v[96:99]
    v_mfma_f32_16x16x32_bf16 v[68:71], v[200:203], v[136:139], v[68:71]
    v_mfma_f32_16x16x32_bf16 v[100:103], v[200:203], v[140:143], v[100:103]
    s_mov_b32 m0, 131072
    s_mov_b32 s68, 0
    buffer_load_dwordx4 v6, s[48:51], s68 offen offset:0 nt lds
    v_xor_b32 v13, 128, v6
    buffer_load_dwordx4 v13, s[48:51], s68 offen offset:1024 nt lds
    v_xor_b32 v13, 16, v6
    buffer_load_dwordx4 v13, s[48:51], s68 offen offset:2048 nt lds
    v_xor_b32 v13, 144, v6
    buffer_load_dwordx4 v13, s[48:51], s68 offen offset:3072 nt lds
    v_mfma_f32_16x16x32_bf16 v[72:75], v[204:207], v[136:139], v[72:75]
    v_mfma_f32_16x16x32_bf16 v[104:107], v[204:207], v[140:143], v[104:107]
    v_mfma_f32_16x16x32_bf16 v[76:79], v[208:211], v[136:139], v[76:79]
    v_mfma_f32_16x16x32_bf16 v[108:111], v[208:211], v[140:143], v[108:111]
    v_mfma_f32_16x16x32_bf16 v[80:83], v[212:215], v[136:139], v[80:83]
    v_mfma_f32_16x16x32_bf16 v[112:115], v[212:215], v[140:143], v[112:115]
    v_mfma_f32_16x16x32_bf16 v[84:87], v[216:219], v[136:139], v[84:87]
    v_mfma_f32_16x16x32_bf16 v[116:119], v[216:219], v[140:143], v[116:119]
    v_mfma_f32_16x16x32_bf16 v[88:91], v[220:223], v[136:139], v[88:91]
    v_mfma_f32_16x16x32_bf16 v[120:123], v[220:223], v[140:143], v[120:123]
    v_mfma_f32_16x16x32_bf16 v[92:95], v[224:227], v[136:139], v[92:95]
    v_mfma_f32_16x16x32_bf16 v[124:127], v[224:227], v[140:143], v[124:127]
    v_mfma_f32_16x16x32_bf16 v[128:131], v[184:187], v[144:147], v[128:131]
    v_mfma_f32_16x16x32_bf16 v[132:135], v[188:191], v[144:147], v[132:135]
    s_waitcnt lgkmcnt(0)
    s_barrier
    v_add_u32 v247, s74, v11
    v_add_u32 v246, s61, v247
    v_add_u32 v228, s75, v10
    v_xor_b32 v229, 32, v228
    v_xor_b32 v230, 64, v228
    v_xor_b32 v231, 96, v228
    v_xor_b32 v232, 128, v228
    v_xor_b32 v233, 160, v228
    v_xor_b32 v234, 192, v228
    v_xor_b32 v235, 224, v228
    s_lshl_b32 s7, s60, 6
    v_xor_b32 v244, s7, v228
    v_xor_b32 v245, 32, v244
    s_add_u32 s75, s75, 8192
    s_sub_u32 s7, s75, s72
    s_cmp_eq_u32 s7, 24576
    s_cselect_b32 s75, s72, s75
    ds_read_b128 v[136:139], v246 offset:0
    ds_read_b128 v[140:143], v246 offset:2048
    ds_read_b128 v[144:147], v247 offset:16384
    ds_read_b64_tr_b16 v[196:197], v228 offset:0
    ds_read_b64_tr_b16 v[198:199], v228 offset:1024
    ds_read_b64_tr_b16 v[200:201], v229 offset:0
    ds_read_b64_tr_b16 v[202:203], v229 offset:1024
    ds_read_b64_tr_b16 v[204:205], v230 offset:0
    ds_read_b64_tr_b16 v[206:207], v230 offset:1024
    ds_read_b64_tr_b16 v[208:209], v231 offset:0
    ds_read_b64_tr_b16 v[210:211], v231 offset:1024
    ds_read_b64_tr_b16 v[212:213], v232 offset:0
    ds_read_b64_tr_b16 v[214:215], v232 offset:1024
    ds_read_b64_tr_b16 v[216:217], v233 offset:0
    ds_read_b64_tr_b16 v[218:219], v233 offset:1024
    ds_read_b64_tr_b16 v[220:221], v234 offset:0
    ds_read_b64_tr_b16 v[222:223], v234 offset:1024
    ds_read_b64_tr_b16 v[224:225], v235 offset:0
    ds_read_b64_tr_b16 v[226:227], v235 offset:1024
    ds_read_b64_tr_b16 v[184:185], v244 offset:0
    ds_read_b64_tr_b16 v[186:187], v244 offset:1024
    ds_read_b64_tr_b16 v[188:189], v245 offset:0
    ds_read_b64_tr_b16 v[190:191], v245 offset:1024
    v_mfma_f32_16x16x32_bf16 v[64:67], v[16:19], v[148:151], v[64:67]
    v_mfma_f32_16x16x32_bf16 v[96:99], v[16:19], v[152:155], v[96:99]
    v_mfma_f32_16x16x32_bf16 v[68:71], v[20:23], v[148:151], v[68:71]
    v_mfma_f32_16x16x32_bf16 v[100:103], v[20:23], v[152:155], v[100:103]
    s_mov_b32 m0, 135168
    s_mov_b32 s68, 4096
    buffer_load_dwordx4 v6, s[48:51], s68 offen offset:0 nt lds
    v_xor_b32 v13, 128, v6
    buffer_load_dwordx4 v13, s[48:51], s68 offen offset:1024 nt lds
    v_xor_b32 v13, 16, v6
    buffer_load_dwordx4 v13, s[48:51], s68 offen offset:2048 nt lds
    v_xor_b32 v13, 144, v6
    buffer_load_dwordx4 v13, s[48:51], s68 offen offset:3072 nt lds
    v_mfma_f32_16x16x32_bf16 v[72:75], v[24:27], v[148:151], v[72:75]
    v_mfma_f32_16x16x32_bf16 v[104:107], v[24:27], v[152:155], v[104:107]
    v_mfma_f32_16x16x32_bf16 v[76:79], v[28:31], v[148:151], v[76:79]
    v_mfma_f32_16x16x32_bf16 v[108:111], v[28:31], v[152:155], v[108:111]
    v_mfma_f32_16x16x32_bf16 v[80:83], v[32:35], v[148:151], v[80:83]
    v_mfma_f32_16x16x32_bf16 v[112:115], v[32:35], v[152:155], v[112:115]
    v_mfma_f32_16x16x32_bf16 v[84:87], v[36:39], v[148:151], v[84:87]
    v_mfma_f32_16x16x32_bf16 v[116:119], v[36:39], v[152:155], v[116:119]
    v_mfma_f32_16x16x32_bf16 v[88:91], v[40:43], v[148:151], v[88:91]
    v_mfma_f32_16x16x32_bf16 v[120:123], v[40:43], v[152:155], v[120:123]
    v_mfma_f32_16x16x32_bf16 v[92:95], v[44:47], v[148:151], v[92:95]
    v_mfma_f32_16x16x32_bf16 v[124:127], v[44:47], v[152:155], v[124:127]
    v_mfma_f32_16x16x32_bf16 v[128:131], v[48:51], v[156:159], v[128:131]
    v_mfma_f32_16x16x32_bf16 v[132:135], v[52:55], v[156:159], v[132:135]
    s_waitcnt lgkmcnt(0)
    s_barrier
    v_xor_b32 v246, 64, v246
    v_xor_b32 v247, 64, v247
    v_add_u32 v228, s75, v10
    v_xor_b32 v229, 32, v228
    v_xor_b32 v230, 64, v228
    v_xor_b32 v231, 96, v228
    v_xor_b32 v232, 128, v228
    v_xor_b32 v233, 160, v228
    v_xor_b32 v234, 192, v228
    v_xor_b32 v235, 224, v228
    s_lshl_b32 s7, s60, 6
    v_xor_b32 v244, s7, v228
    v_xor_b32 v245, 32, v244
    s_add_u32 s75, s75, 8192
    s_sub_u32 s7, s75, s72
    s_cmp_eq_u32 s7, 24576
    s_cselect_b32 s75, s72, s75
    ds_read_b128 v[148:151], v246 offset:0
    ds_read_b128 v[152:155], v246 offset:2048
    ds_read_b128 v[156:159], v247 offset:16384
    ds_read_b64_tr_b16 v[16:17], v228 offset:0
    ds_read_b64_tr_b16 v[18:19], v228 offset:1024
    ds_read_b64_tr_b16 v[20:21], v229 offset:0
    ds_read_b64_tr_b16 v[22:23], v229 offset:1024
    ds_read_b64_tr_b16 v[24:25], v230 offset:0
    ds_read_b64_tr_b16 v[26:27], v230 offset:1024
    ds_read_b64_tr_b16 v[28:29], v231 offset:0
    ds_read_b64_tr_b16 v[30:31], v231 offset:1024
    ds_read_b64_tr_b16 v[32:33], v232 offset:0
    ds_read_b64_tr_b16 v[34:35], v232 offset:1024
    ds_read_b64_tr_b16 v[36:37], v233 offset:0
    ds_read_b64_tr_b16 v[38:39], v233 offset:1024
    ds_read_b64_tr_b16 v[40:41], v234 offset:0
    ds_read_b64_tr_b16 v[42:43], v234 offset:1024
    ds_read_b64_tr_b16 v[44:45], v235 offset:0
    ds_read_b64_tr_b16 v[46:47], v235 offset:1024
    ds_read_b64_tr_b16 v[48:49], v244 offset:0
    ds_read_b64_tr_b16 v[50:51], v244 offset:1024
    ds_read_b64_tr_b16 v[52:53], v245 offset:0
    ds_read_b64_tr_b16 v[54:55], v245 offset:1024
    s_mov_b32 s7, s74
    s_mov_b32 s74, s39
    s_mov_b32 s39, s7
    v_mfma_f32_16x16x32_bf16 v[64:67], v[196:199], v[136:139], v[64:67]
    v_mfma_f32_16x16x32_bf16 v[96:99], v[196:199], v[140:143], v[96:99]
    v_mfma_f32_16x16x32_bf16 v[68:71], v[200:203], v[136:139], v[68:71]
    v_mfma_f32_16x16x32_bf16 v[100:103], v[200:203], v[140:143], v[100:103]
    s_mov_b32 m0, 139264
    s_mov_b32 s68, 8192
    buffer_load_dwordx4 v6, s[48:51], s68 offen offset:0 nt lds
    v_xor_b32 v13, 128, v6
    buffer_load_dwordx4 v13, s[48:51], s68 offen offset:1024 nt lds
    v_xor_b32 v13, 16, v6
    buffer_load_dwordx4 v13, s[48:51], s68 offen offset:2048 nt lds
    v_xor_b32 v13, 144, v6
    buffer_load_dwordx4 v13, s[48:51], s68 offen offset:3072 nt lds
    v_mfma_f32_16x16x32_bf16 v[72:75], v[204:207], v[136:139], v[72:75]
    v_mfma_f32_16x16x32_bf16 v[104:107], v[204:207], v[140:143], v[104:107]
    v_mfma_f32_16x16x32_bf16 v[76:79], v[208:211], v[136:139], v[76:79]
    v_mfma_f32_16x16x32_bf16 v[108:111], v[208:211], v[140:143], v[108:111]
    v_mfma_f32_16x16x32_bf16 v[80:83], v[212:215], v[136:139], v[80:83]
    v_mfma_f32_16x16x32_bf16 v[112:115], v[212:215], v[140:143], v[112:115]
    v_mfma_f32_16x16x32_bf16 v[84:87], v[216:219], v[136:139], v[84:87]
    v_mfma_f32_16x16x32_bf16 v[116:119], v[216:219], v[140:143], v[116:119]
    v_mfma_f32_16x16x32_bf16 v[88:91], v[220:223], v[136:139], v[88:91]
    v_mfma_f32_16x16x32_bf16 v[120:123], v[220:223], v[140:143], v[120:123]
    v_mfma_f32_16x16x32_bf16 v[92:95], v[224:227], v[136:139], v[92:95]
    v_mfma_f32_16x16x32_bf16 v[124:127], v[224:227], v[140:143], v[124:127]
    v_mfma_f32_16x16x32_bf16 v[128:131], v[184:187], v[144:147], v[128:131]
    v_mfma_f32_16x16x32_bf16 v[132:135], v[188:191], v[144:147], v[132:135]
    s_waitcnt lgkmcnt(0)
    s_barrier
    v_add_u32 v247, s74, v11
    v_add_u32 v246, s61, v247
    v_add_u32 v228, s75, v10
    v_xor_b32 v229, 32, v228
    v_xor_b32 v230, 64, v228
    v_xor_b32 v231, 96, v228
    v_xor_b32 v232, 128, v228
    v_xor_b32 v233, 160, v228
    v_xor_b32 v234, 192, v228
    v_xor_b32 v235, 224, v228
    s_lshl_b32 s7, s60, 6
    v_xor_b32 v244, s7, v228
    v_xor_b32 v245, 32, v244
    s_add_u32 s75, s75, 8192
    s_sub_u32 s7, s75, s72
    s_cmp_eq_u32 s7, 24576
    s_cselect_b32 s75, s72, s75
    ds_read_b128 v[136:139], v246 offset:0
    ds_read_b128 v[140:143], v246 offset:2048
    ds_read_b128 v[144:147], v247 offset:16384
    ds_read_b64_tr_b16 v[196:197], v228 offset:0
    ds_read_b64_tr_b16 v[198:199], v228 offset:1024
    ds_read_b64_tr_b16 v[200:201], v229 offset:0
    ds_read_b64_tr_b16 v[202:203], v229 offset:1024
    ds_read_b64_tr_b16 v[204:205], v230 offset:0
    ds_read_b64_tr_b16 v[206:207], v230 offset:1024
    ds_read_b64_tr_b16 v[208:209], v231 offset:0
    ds_read_b64_tr_b16 v[210:211], v231 offset:1024
    ds_read_b64_tr_b16 v[212:213], v232 offset:0
    ds_read_b64_tr_b16 v[214:215], v232 offset:1024
    ds_read_b64_tr_b16 v[216:217], v233 offset:0
    ds_read_b64_tr_b16 v[218:219], v233 offset:1024
    ds_read_b64_tr_b16 v[220:221], v234 offset:0
    ds_read_b64_tr_b16 v[222:223], v234 offset:1024
    ds_read_b64_tr_b16 v[224:225], v235 offset:0
    ds_read_b64_tr_b16 v[226:227], v235 offset:1024
    ds_read_b64_tr_b16 v[184:185], v244 offset:0
    ds_read_b64_tr_b16 v[186:187], v244 offset:1024
    ds_read_b64_tr_b16 v[188:189], v245 offset:0
    ds_read_b64_tr_b16 v[190:191], v245 offset:1024
    v_mfma_f32_16x16x32_bf16 v[64:67], v[16:19], v[148:151], v[64:67]
    v_mfma_f32_16x16x32_bf16 v[96:99], v[16:19], v[152:155], v[96:99]
    v_mfma_f32_16x16x32_bf16 v[68:71], v[20:23], v[148:151], v[68:71]
    v_mfma_f32_16x16x32_bf16 v[100:103], v[20:23], v[152:155], v[100:103]
    s_mov_b32 m0, 143360
    s_mov_b32 s68, 12288
    buffer_load_dwordx4 v6, s[48:51], s68 offen offset:0 nt lds
    v_xor_b32 v13, 128, v6
    buffer_load_dwordx4 v13, s[48:51], s68 offen offset:1024 nt lds
    v_xor_b32 v13, 16, v6
    buffer_load_dwordx4 v13, s[48:51], s68 offen offset:2048 nt lds
    v_xor_b32 v13, 144, v6
    buffer_load_dwordx4 v13, s[48:51], s68 offen offset:3072 nt lds
    v_mfma_f32_16x16x32_bf16 v[72:75], v[24:27], v[148:151], v[72:75]
    v_mfma_f32_16x16x32_bf16 v[104:107], v[24:27], v[152:155], v[104:107]
    v_mfma_f32_16x16x32_bf16 v[76:79], v[28:31], v[148:151], v[76:79]
    v_mfma_f32_16x16x32_bf16 v[108:111], v[28:31], v[152:155], v[108:111]
    v_mfma_f32_16x16x32_bf16 v[80:83], v[32:35], v[148:151], v[80:83]
    v_mfma_f32_16x16x32_bf16 v[112:115], v[32:35], v[152:155], v[112:115]
    v_mfma_f32_16x16x32_bf16 v[84:87], v[36:39], v[148:151], v[84:87]
    v_mfma_f32_16x16x32_bf16 v[116:119], v[36:39], v[152:155], v[116:119]
    v_mfma_f32_16x16x32_bf16 v[88:91], v[40:43], v[148:151], v[88:91]
    v_mfma_f32_16x16x32_bf16 v[120:123], v[40:43], v[152:155], v[120:123]
    v_mfma_f32_16x16x32_bf16 v[92:95], v[44:47], v[148:151], v[92:95]
    v_mfma_f32_16x16x32_bf16 v[124:127], v[44:47], v[152:155], v[124:127]
    v_mfma_f32_16x16x32_bf16 v[128:131], v[48:51], v[156:159], v[128:131]
    v_mfma_f32_16x16x32_bf16 v[132:135], v[52:55], v[156:159], v[132:135]
    s_waitcnt lgkmcnt(0)
    s_barrier
    v_xor_b32 v246, 64, v246
    v_xor_b32 v247, 64, v247
    v_add_u32 v228, s75, v10
    v_xor_b32 v229, 32, v228
    v_xor_b32 v230, 64, v228
    v_xor_b32 v231, 96, v228
    v_xor_b32 v232, 128, v228
    v_xor_b32 v233, 160, v228
    v_xor_b32 v234, 192, v228
    v_xor_b32 v235, 224, v228
    s_lshl_b32 s7, s60, 6
    v_xor_b32 v244, s7, v228
    v_xor_b32 v245, 32, v244
    s_add_u32 s75, s75, 8192
    s_sub_u32 s7, s75, s72
    s_cmp_eq_u32 s7, 24576
    s_cselect_b32 s75, s72, s75
    ds_read_b128 v[148:151], v246 offset:0
    ds_read_b128 v[152:155], v246 offset:2048
    ds_read_b128 v[156:159], v247 offset:16384
    ds_read_b64_tr_b16 v[16:17], v228 offset:0
    ds_read_b64_tr_b16 v[18:19], v228 offset:1024
    ds_read_b64_tr_b16 v[20:21], v229 offset:0
    ds_read_b64_tr_b16 v[22:23], v229 offset:1024
    ds_read_b64_tr_b16 v[24:25], v230 offset:0
    ds_read_b64_tr_b16 v[26:27], v230 offset:1024
    ds_read_b64_tr_b16 v[28:29], v231 offset:0
    ds_read_b64_tr_b16 v[30:31], v231 offset:1024
    ds_read_b64_tr_b16 v[32:33], v232 offset:0
    ds_read_b64_tr_b16 v[34:35], v232 offset:1024
    ds_read_b64_tr_b16 v[36:37], v233 offset:0
    ds_read_b64_tr_b16 v[38:39], v233 offset:1024
    ds_read_b64_tr_b16 v[40:41], v234 offset:0
    ds_read_b64_tr_b16 v[42:43], v234 offset:1024
    ds_read_b64_tr_b16 v[44:45], v235 offset:0
    ds_read_b64_tr_b16 v[46:47], v235 offset:1024
    ds_read_b64_tr_b16 v[48:49], v244 offset:0
    ds_read_b64_tr_b16 v[50:51], v244 offset:1024
    ds_read_b64_tr_b16 v[52:53], v245 offset:0
    ds_read_b64_tr_b16 v[54:55], v245 offset:1024
    s_mov_b32 s7, s74
    s_mov_b32 s74, s39
    s_mov_b32 s39, s7
    v_mfma_f32_16x16x32_bf16 v[64:67], v[196:199], v[136:139], v[64:67]
    v_mfma_f32_16x16x32_bf16 v[96:99], v[196:199], v[140:143], v[96:99]
    v_mfma_f32_16x16x32_bf16 v[68:71], v[200:203], v[136:139], v[68:71]
    v_mfma_f32_16x16x32_bf16 v[100:103], v[200:203], v[140:143], v[100:103]
    s_mov_b32 m0, 65536
    s_mov_b32 s68, 0
    buffer_load_dwordx4 v6, s[20:23], s68 offen offset:0 nt lds
    v_xor_b32 v13, 128, v6
    buffer_load_dwordx4 v13, s[20:23], s68 offen offset:1024 nt lds
    v_xor_b32 v13, 16, v6
    buffer_load_dwordx4 v13, s[20:23], s68 offen offset:2048 nt lds
    v_xor_b32 v13, 144, v6
    buffer_load_dwordx4 v13, s[20:23], s68 offen offset:3072 nt lds
    v_mfma_f32_16x16x32_bf16 v[72:75], v[204:207], v[136:139], v[72:75]
    v_mfma_f32_16x16x32_bf16 v[104:107], v[204:207], v[140:143], v[104:107]
    v_mfma_f32_16x16x32_bf16 v[76:79], v[208:211], v[136:139], v[76:79]
    v_mfma_f32_16x16x32_bf16 v[108:111], v[208:211], v[140:143], v[108:111]
    v_mfma_f32_16x16x32_bf16 v[80:83], v[212:215], v[136:139], v[80:83]
    v_mfma_f32_16x16x32_bf16 v[112:115], v[212:215], v[140:143], v[112:115]
    v_mfma_f32_16x16x32_bf16 v[84:87], v[216:219], v[136:139], v[84:87]
    v_mfma_f32_16x16x32_bf16 v[116:119], v[216:219], v[140:143], v[116:119]
    v_mfma_f32_16x16x32_bf16 v[88:91], v[220:223], v[136:139], v[88:91]
    v_mfma_f32_16x16x32_bf16 v[120:123], v[220:223], v[140:143], v[120:123]
    v_mfma_f32_16x16x32_bf16 v[92:95], v[224:227], v[136:139], v[92:95]
    v_mfma_f32_16x16x32_bf16 v[124:127], v[224:227], v[140:143], v[124:127]
    v_mfma_f32_16x16x32_bf16 v[128:131], v[184:187], v[144:147], v[128:131]
    v_mfma_f32_16x16x32_bf16 v[132:135], v[188:191], v[144:147], v[132:135]
    s_waitcnt lgkmcnt(0)
    s_barrier
    v_add_u32 v247, s74, v11
    v_add_u32 v246, s61, v247
    v_add_u32 v228, s75, v10
    v_xor_b32 v229, 32, v228
    v_xor_b32 v230, 64, v228
    v_xor_b32 v231, 96, v228
    v_xor_b32 v232, 128, v228
    v_xor_b32 v233, 160, v228
    v_xor_b32 v234, 192, v228
    v_xor_b32 v235, 224, v228
    s_lshl_b32 s7, s60, 6
    v_xor_b32 v244, s7, v228
    v_xor_b32 v245, 32, v244
    s_add_u32 s75, s75, 8192
    s_sub_u32 s7, s75, s72
    s_cmp_eq_u32 s7, 24576
    s_cselect_b32 s75, s72, s75
    ds_read_b128 v[136:139], v246 offset:0
    ds_read_b128 v[140:143], v246 offset:2048
    ds_read_b128 v[144:147], v247 offset:16384
    ds_read_b64_tr_b16 v[196:197], v228 offset:0
    ds_read_b64_tr_b16 v[198:199], v228 offset:1024
    ds_read_b64_tr_b16 v[200:201], v229 offset:0
    ds_read_b64_tr_b16 v[202:203], v229 offset:1024
    ds_read_b64_tr_b16 v[204:205], v230 offset:0
    ds_read_b64_tr_b16 v[206:207], v230 offset:1024
    ds_read_b64_tr_b16 v[208:209], v231 offset:0
    ds_read_b64_tr_b16 v[210:211], v231 offset:1024
    ds_read_b64_tr_b16 v[212:213], v232 offset:0
    ds_read_b64_tr_b16 v[214:215], v232 offset:1024
    ds_read_b64_tr_b16 v[216:217], v233 offset:0
    ds_read_b64_tr_b16 v[218:219], v233 offset:1024
    ds_read_b64_tr_b16 v[220:221], v234 offset:0
    ds_read_b64_tr_b16 v[222:223], v234 offset:1024
    ds_read_b64_tr_b16 v[224:225], v235 offset:0
    ds_read_b64_tr_b16 v[226:227], v235 offset:1024
    ds_read_b64_tr_b16 v[184:185], v244 offset:0
    ds_read_b64_tr_b16 v[186:187], v244 offset:1024
    ds_read_b64_tr_b16 v[188:189], v245 offset:0
    ds_read_b64_tr_b16 v[190:191], v245 offset:1024
    v_mfma_f32_16x16x32_bf16 v[64:67], v[16:19], v[148:151], v[64:67]
    v_mfma_f32_16x16x32_bf16 v[96:99], v[16:19], v[152:155], v[96:99]
    v_mfma_f32_16x16x32_bf16 v[68:71], v[20:23], v[148:151], v[68:71]
    v_mfma_f32_16x16x32_bf16 v[100:103], v[20:23], v[152:155], v[100:103]
    s_mov_b32 m0, 69632
    s_mov_b32 s68, 4096
    buffer_load_dwordx4 v6, s[20:23], s68 offen offset:0 nt lds
    v_xor_b32 v13, 128, v6
    buffer_load_dwordx4 v13, s[20:23], s68 offen offset:1024 nt lds
    v_xor_b32 v13, 16, v6
    buffer_load_dwordx4 v13, s[20:23], s68 offen offset:2048 nt lds
    v_xor_b32 v13, 144, v6
    buffer_load_dwordx4 v13, s[20:23], s68 offen offset:3072 nt lds
    v_mfma_f32_16x16x32_bf16 v[72:75], v[24:27], v[148:151], v[72:75]
    v_mfma_f32_16x16x32_bf16 v[104:107], v[24:27], v[152:155], v[104:107]
    v_mfma_f32_16x16x32_bf16 v[76:79], v[28:31], v[148:151], v[76:79]
    v_mfma_f32_16x16x32_bf16 v[108:111], v[28:31], v[152:155], v[108:111]
    v_mfma_f32_16x16x32_bf16 v[80:83], v[32:35], v[148:151], v[80:83]
    v_mfma_f32_16x16x32_bf16 v[112:115], v[32:35], v[152:155], v[112:115]
    v_mfma_f32_16x16x32_bf16 v[84:87], v[36:39], v[148:151], v[84:87]
    v_mfma_f32_16x16x32_bf16 v[116:119], v[36:39], v[152:155], v[116:119]
    v_mfma_f32_16x16x32_bf16 v[88:91], v[40:43], v[148:151], v[88:91]
    v_mfma_f32_16x16x32_bf16 v[120:123], v[40:43], v[152:155], v[120:123]
    v_mfma_f32_16x16x32_bf16 v[92:95], v[44:47], v[148:151], v[92:95]
    v_mfma_f32_16x16x32_bf16 v[124:127], v[44:47], v[152:155], v[124:127]
    v_mfma_f32_16x16x32_bf16 v[128:131], v[48:51], v[156:159], v[128:131]
    v_mfma_f32_16x16x32_bf16 v[132:135], v[52:55], v[156:159], v[132:135]
    s_waitcnt lgkmcnt(0)
    s_barrier
    v_xor_b32 v246, 64, v246
    v_xor_b32 v247, 64, v247
    v_add_u32 v228, s75, v10
    v_xor_b32 v229, 32, v228
    v_xor_b32 v230, 64, v228
    v_xor_b32 v231, 96, v228
    v_xor_b32 v232, 128, v228
    v_xor_b32 v233, 160, v228
    v_xor_b32 v234, 192, v228
    v_xor_b32 v235, 224, v228
    s_lshl_b32 s7, s60, 6
    v_xor_b32 v244, s7, v228
    v_xor_b32 v245, 32, v244
    s_add_u32 s75, s75, 8192
    s_sub_u32 s7, s75, s72
    s_cmp_eq_u32 s7, 24576
    s_cselect_b32 s75, s72, s75
    ds_read_b128 v[148:151], v246 offset:0
    ds_read_b128 v[152:155], v246 offset:2048
    ds_read_b128 v[156:159], v247 offset:16384
    ds_read_b64_tr_b16 v[16:17], v228 offset:0
    ds_read_b64_tr_b16 v[18:19], v228 offset:1024
    ds_read_b64_tr_b16 v[20:21], v229 offset:0
    ds_read_b64_tr_b16 v[22:23], v229 offset:1024
    ds_read_b64_tr_b16 v[24:25], v230 offset:0
    ds_read_b64_tr_b16 v[26:27], v230 offset:1024
    ds_read_b64_tr_b16 v[28:29], v231 offset:0
    ds_read_b64_tr_b16 v[30:31], v231 offset:1024
    ds_read_b64_tr_b16 v[32:33], v232 offset:0
    ds_read_b64_tr_b16 v[34:35], v232 offset:1024
    ds_read_b64_tr_b16 v[36:37], v233 offset:0
    ds_read_b64_tr_b16 v[38:39], v233 offset:1024
    ds_read_b64_tr_b16 v[40:41], v234 offset:0
    ds_read_b64_tr_b16 v[42:43], v234 offset:1024
    ds_read_b64_tr_b16 v[44:45], v235 offset:0
    ds_read_b64_tr_b16 v[46:47], v235 offset:1024
    ds_read_b64_tr_b16 v[48:49], v244 offset:0
    ds_read_b64_tr_b16 v[50:51], v244 offset:1024
    ds_read_b64_tr_b16 v[52:53], v245 offset:0
    ds_read_b64_tr_b16 v[54:55], v245 offset:1024
    s_mov_b32 s7, s74
    s_mov_b32 s74, s39
    s_mov_b32 s39, s7
    v_mfma_f32_16x16x32_bf16 v[64:67], v[196:199], v[136:139], v[64:67]
    v_mfma_f32_16x16x32_bf16 v[96:99], v[196:199], v[140:143], v[96:99]
    v_mfma_f32_16x16x32_bf16 v[68:71], v[200:203], v[136:139], v[68:71]
    v_mfma_f32_16x16x32_bf16 v[100:103], v[200:203], v[140:143], v[100:103]
    s_mov_b32 m0, 73728
    s_mov_b32 s68, 8192
    buffer_load_dwordx4 v6, s[20:23], s68 offen offset:0 nt lds
    v_xor_b32 v13, 128, v6
    buffer_load_dwordx4 v13, s[20:23], s68 offen offset:1024 nt lds
    v_xor_b32 v13, 16, v6
    buffer_load_dwordx4 v13, s[20:23], s68 offen offset:2048 nt lds
    v_xor_b32 v13, 144, v6
    buffer_load_dwordx4 v13, s[20:23], s68 offen offset:3072 nt lds
    v_mfma_f32_16x16x32_bf16 v[72:75], v[204:207], v[136:139], v[72:75]
    v_mfma_f32_16x16x32_bf16 v[104:107], v[204:207], v[140:143], v[104:107]
    v_mfma_f32_16x16x32_bf16 v[76:79], v[208:211], v[136:139], v[76:79]
    v_mfma_f32_16x16x32_bf16 v[108:111], v[208:211], v[140:143], v[108:111]
    v_mfma_f32_16x16x32_bf16 v[80:83], v[212:215], v[136:139], v[80:83]
    v_mfma_f32_16x16x32_bf16 v[112:115], v[212:215], v[140:143], v[112:115]
    v_mfma_f32_16x16x32_bf16 v[84:87], v[216:219], v[136:139], v[84:87]
    v_mfma_f32_16x16x32_bf16 v[116:119], v[216:219], v[140:143], v[116:119]
    v_mfma_f32_16x16x32_bf16 v[88:91], v[220:223], v[136:139], v[88:91]
    v_mfma_f32_16x16x32_bf16 v[120:123], v[220:223], v[140:143], v[120:123]
    v_mfma_f32_16x16x32_bf16 v[92:95], v[224:227], v[136:139], v[92:95]
    v_mfma_f32_16x16x32_bf16 v[124:127], v[224:227], v[140:143], v[124:127]
    v_mfma_f32_16x16x32_bf16 v[128:131], v[184:187], v[144:147], v[128:131]
    v_mfma_f32_16x16x32_bf16 v[132:135], v[188:191], v[144:147], v[132:135]
    s_waitcnt lgkmcnt(0)
    s_barrier
    v_add_u32 v247, s74, v11
    v_add_u32 v246, s61, v247
    v_add_u32 v228, s75, v10
    v_xor_b32 v229, 32, v228
    v_xor_b32 v230, 64, v228
    v_xor_b32 v231, 96, v228
    v_xor_b32 v232, 128, v228
    v_xor_b32 v233, 160, v228
    v_xor_b32 v234, 192, v228
    v_xor_b32 v235, 224, v228
    s_lshl_b32 s7, s60, 6
    v_xor_b32 v244, s7, v228
    v_xor_b32 v245, 32, v244
    s_add_u32 s75, s75, 8192
    s_sub_u32 s7, s75, s72
    s_cmp_eq_u32 s7, 24576
    s_cselect_b32 s75, s72, s75
    ds_read_b128 v[136:139], v246 offset:0
    ds_read_b128 v[140:143], v246 offset:2048
    ds_read_b128 v[144:147], v247 offset:16384
    ds_read_b64_tr_b16 v[196:197], v228 offset:0
    ds_read_b64_tr_b16 v[198:199], v228 offset:1024
    ds_read_b64_tr_b16 v[200:201], v229 offset:0
    ds_read_b64_tr_b16 v[202:203], v229 offset:1024
    ds_read_b64_tr_b16 v[204:205], v230 offset:0
    ds_read_b64_tr_b16 v[206:207], v230 offset:1024
    ds_read_b64_tr_b16 v[208:209], v231 offset:0
    ds_read_b64_tr_b16 v[210:211], v231 offset:1024
    ds_read_b64_tr_b16 v[212:213], v232 offset:0
    ds_read_b64_tr_b16 v[214:215], v232 offset:1024
    ds_read_b64_tr_b16 v[216:217], v233 offset:0
    ds_read_b64_tr_b16 v[218:219], v233 offset:1024
    ds_read_b64_tr_b16 v[220:221], v234 offset:0
    ds_read_b64_tr_b16 v[222:223], v234 offset:1024
    ds_read_b64_tr_b16 v[224:225], v235 offset:0
    ds_read_b64_tr_b16 v[226:227], v235 offset:1024
    ds_read_b64_tr_b16 v[184:185], v244 offset:0
    ds_read_b64_tr_b16 v[186:187], v244 offset:1024
    ds_read_b64_tr_b16 v[188:189], v245 offset:0
    ds_read_b64_tr_b16 v[190:191], v245 offset:1024
    v_mfma_f32_16x16x32_bf16 v[64:67], v[16:19], v[148:151], v[64:67]
    v_mfma_f32_16x16x32_bf16 v[96:99], v[16:19], v[152:155], v[96:99]
    v_mfma_f32_16x16x32_bf16 v[68:71], v[20:23], v[148:151], v[68:71]
    v_mfma_f32_16x16x32_bf16 v[100:103], v[20:23], v[152:155], v[100:103]
    s_mov_b32 m0, 77824
    s_mov_b32 s68, 12288
    buffer_load_dwordx4 v6, s[20:23], s68 offen offset:0 nt lds
    v_xor_b32 v13, 128, v6
    buffer_load_dwordx4 v13, s[20:23], s68 offen offset:1024 nt lds
    v_xor_b32 v13, 16, v6
    buffer_load_dwordx4 v13, s[20:23], s68 offen offset:2048 nt lds
    v_xor_b32 v13, 144, v6
    buffer_load_dwordx4 v13, s[20:23], s68 offen offset:3072 nt lds
    v_mfma_f32_16x16x32_bf16 v[72:75], v[24:27], v[148:151], v[72:75]
    v_mfma_f32_16x16x32_bf16 v[104:107], v[24:27], v[152:155], v[104:107]
    v_mfma_f32_16x16x32_bf16 v[76:79], v[28:31], v[148:151], v[76:79]
    v_mfma_f32_16x16x32_bf16 v[108:111], v[28:31], v[152:155], v[108:111]
    v_mfma_f32_16x16x32_bf16 v[80:83], v[32:35], v[148:151], v[80:83]
    v_mfma_f32_16x16x32_bf16 v[112:115], v[32:35], v[152:155], v[112:115]
    v_mfma_f32_16x16x32_bf16 v[84:87], v[36:39], v[148:151], v[84:87]
    v_mfma_f32_16x16x32_bf16 v[116:119], v[36:39], v[152:155], v[116:119]
    v_mfma_f32_16x16x32_bf16 v[88:91], v[40:43], v[148:151], v[88:91]
    v_mfma_f32_16x16x32_bf16 v[120:123], v[40:43], v[152:155], v[120:123]
    v_mfma_f32_16x16x32_bf16 v[92:95], v[44:47], v[148:151], v[92:95]
    v_mfma_f32_16x16x32_bf16 v[124:127], v[44:47], v[152:155], v[124:127]
    v_mfma_f32_16x16x32_bf16 v[128:131], v[48:51], v[156:159], v[128:131]
    v_mfma_f32_16x16x32_bf16 v[132:135], v[52:55], v[156:159], v[132:135]
    s_waitcnt lgkmcnt(0)
    s_barrier
    v_xor_b32 v246, 64, v246
    v_xor_b32 v247, 64, v247
    v_add_u32 v228, s75, v10
    v_xor_b32 v229, 32, v228
    v_xor_b32 v230, 64, v228
    v_xor_b32 v231, 96, v228
    v_xor_b32 v232, 128, v228
    v_xor_b32 v233, 160, v228
    v_xor_b32 v234, 192, v228
    v_xor_b32 v235, 224, v228
    s_lshl_b32 s7, s60, 6
    v_xor_b32 v244, s7, v228
    v_xor_b32 v245, 32, v244
    s_add_u32 s75, s75, 8192
    s_sub_u32 s7, s75, s72
    s_cmp_eq_u32 s7, 24576
    s_cselect_b32 s75, s72, s75
    ds_read_b128 v[148:151], v246 offset:0
    ds_read_b128 v[152:155], v246 offset:2048
    ds_read_b128 v[156:159], v247 offset:16384
    ds_read_b64_tr_b16 v[16:17], v228 offset:0
    ds_read_b64_tr_b16 v[18:19], v228 offset:1024
    ds_read_b64_tr_b16 v[20:21], v229 offset:0
    ds_read_b64_tr_b16 v[22:23], v229 offset:1024
    ds_read_b64_tr_b16 v[24:25], v230 offset:0
    ds_read_b64_tr_b16 v[26:27], v230 offset:1024
    ds_read_b64_tr_b16 v[28:29], v231 offset:0
    ds_read_b64_tr_b16 v[30:31], v231 offset:1024
    ds_read_b64_tr_b16 v[32:33], v232 offset:0
    ds_read_b64_tr_b16 v[34:35], v232 offset:1024
    ds_read_b64_tr_b16 v[36:37], v233 offset:0
    ds_read_b64_tr_b16 v[38:39], v233 offset:1024
    ds_read_b64_tr_b16 v[40:41], v234 offset:0
    ds_read_b64_tr_b16 v[42:43], v234 offset:1024
    ds_read_b64_tr_b16 v[44:45], v235 offset:0
    ds_read_b64_tr_b16 v[46:47], v235 offset:1024
    ds_read_b64_tr_b16 v[48:49], v244 offset:0
    ds_read_b64_tr_b16 v[50:51], v244 offset:1024
    ds_read_b64_tr_b16 v[52:53], v245 offset:0
    ds_read_b64_tr_b16 v[54:55], v245 offset:1024
    s_mov_b32 s7, s74
    s_mov_b32 s74, s39
    s_mov_b32 s39, s7
    v_mfma_f32_16x16x32_bf16 v[64:67], v[196:199], v[136:139], v[64:67]
    v_mfma_f32_16x16x32_bf16 v[96:99], v[196:199], v[140:143], v[96:99]
    v_mfma_f32_16x16x32_bf16 v[68:71], v[200:203], v[136:139], v[68:71]
    v_mfma_f32_16x16x32_bf16 v[100:103], v[200:203], v[140:143], v[100:103]
    s_mov_b32 m0, 147456
    s_mov_b32 s68, 0
    buffer_load_dwordx4 v6, s[52:55], s68 offen offset:0 nt lds
    v_xor_b32 v13, 128, v6
    buffer_load_dwordx4 v13, s[52:55], s68 offen offset:1024 nt lds
    v_xor_b32 v13, 16, v6
    buffer_load_dwordx4 v13, s[52:55], s68 offen offset:2048 nt lds
    v_xor_b32 v13, 144, v6
    buffer_load_dwordx4 v13, s[52:55], s68 offen offset:3072 nt lds
    v_mfma_f32_16x16x32_bf16 v[72:75], v[204:207], v[136:139], v[72:75]
    v_mfma_f32_16x16x32_bf16 v[104:107], v[204:207], v[140:143], v[104:107]
    v_mfma_f32_16x16x32_bf16 v[76:79], v[208:211], v[136:139], v[76:79]
    v_mfma_f32_16x16x32_bf16 v[108:111], v[208:211], v[140:143], v[108:111]
    v_mfma_f32_16x16x32_bf16 v[80:83], v[212:215], v[136:139], v[80:83]
    v_mfma_f32_16x16x32_bf16 v[112:115], v[212:215], v[140:143], v[112:115]
    v_mfma_f32_16x16x32_bf16 v[84:87], v[216:219], v[136:139], v[84:87]
    v_mfma_f32_16x16x32_bf16 v[116:119], v[216:219], v[140:143], v[116:119]
    v_mfma_f32_16x16x32_bf16 v[88:91], v[220:223], v[136:139], v[88:91]
    v_mfma_f32_16x16x32_bf16 v[120:123], v[220:223], v[140:143], v[120:123]
    v_mfma_f32_16x16x32_bf16 v[92:95], v[224:227], v[136:139], v[92:95]
    v_mfma_f32_16x16x32_bf16 v[124:127], v[224:227], v[140:143], v[124:127]
    v_mfma_f32_16x16x32_bf16 v[128:131], v[184:187], v[144:147], v[128:131]
    v_mfma_f32_16x16x32_bf16 v[132:135], v[188:191], v[144:147], v[132:135]
    s_waitcnt lgkmcnt(0)
    s_barrier
    v_add_u32 v247, s74, v11
    v_add_u32 v246, s61, v247
    v_add_u32 v228, s75, v10
    v_xor_b32 v229, 32, v228
    v_xor_b32 v230, 64, v228
    v_xor_b32 v231, 96, v228
    v_xor_b32 v232, 128, v228
    v_xor_b32 v233, 160, v228
    v_xor_b32 v234, 192, v228
    v_xor_b32 v235, 224, v228
    s_lshl_b32 s7, s60, 6
    v_xor_b32 v244, s7, v228
    v_xor_b32 v245, 32, v244
    s_add_u32 s75, s75, 8192
    s_sub_u32 s7, s75, s72
    s_cmp_eq_u32 s7, 24576
    s_cselect_b32 s75, s72, s75
    ds_read_b128 v[136:139], v246 offset:0
    ds_read_b128 v[140:143], v246 offset:2048
    ds_read_b128 v[144:147], v247 offset:16384
    ds_read_b64_tr_b16 v[196:197], v228 offset:0
    ds_read_b64_tr_b16 v[198:199], v228 offset:1024
    ds_read_b64_tr_b16 v[200:201], v229 offset:0
    ds_read_b64_tr_b16 v[202:203], v229 offset:1024
    ds_read_b64_tr_b16 v[204:205], v230 offset:0
    ds_read_b64_tr_b16 v[206:207], v230 offset:1024
    ds_read_b64_tr_b16 v[208:209], v231 offset:0
    ds_read_b64_tr_b16 v[210:211], v231 offset:1024
    ds_read_b64_tr_b16 v[212:213], v232 offset:0
    ds_read_b64_tr_b16 v[214:215], v232 offset:1024
    ds_read_b64_tr_b16 v[216:217], v233 offset:0
    ds_read_b64_tr_b16 v[218:219], v233 offset:1024
    ds_read_b64_tr_b16 v[220:221], v234 offset:0
    ds_read_b64_tr_b16 v[222:223], v234 offset:1024
    ds_read_b64_tr_b16 v[224:225], v235 offset:0
    ds_read_b64_tr_b16 v[226:227], v235 offset:1024
    ds_read_b64_tr_b16 v[184:185], v244 offset:0
    ds_read_b64_tr_b16 v[186:187], v244 offset:1024
    ds_read_b64_tr_b16 v[188:189], v245 offset:0
    ds_read_b64_tr_b16 v[190:191], v245 offset:1024
    v_mfma_f32_16x16x32_bf16 v[64:67], v[16:19], v[148:151], v[64:67]
    v_mfma_f32_16x16x32_bf16 v[96:99], v[16:19], v[152:155], v[96:99]
    v_mfma_f32_16x16x32_bf16 v[68:71], v[20:23], v[148:151], v[68:71]
    v_mfma_f32_16x16x32_bf16 v[100:103], v[20:23], v[152:155], v[100:103]
    s_mov_b32 m0, 151552
    s_mov_b32 s68, 4096
    buffer_load_dwordx4 v6, s[52:55], s68 offen offset:0 nt lds
    v_xor_b32 v13, 128, v6
    buffer_load_dwordx4 v13, s[52:55], s68 offen offset:1024 nt lds
    v_xor_b32 v13, 16, v6
    buffer_load_dwordx4 v13, s[52:55], s68 offen offset:2048 nt lds
    v_xor_b32 v13, 144, v6
    buffer_load_dwordx4 v13, s[52:55], s68 offen offset:3072 nt lds
    v_mfma_f32_16x16x32_bf16 v[72:75], v[24:27], v[148:151], v[72:75]
    v_mfma_f32_16x16x32_bf16 v[104:107], v[24:27], v[152:155], v[104:107]
    v_mfma_f32_16x16x32_bf16 v[76:79], v[28:31], v[148:151], v[76:79]
    v_mfma_f32_16x16x32_bf16 v[108:111], v[28:31], v[152:155], v[108:111]
    v_mfma_f32_16x16x32_bf16 v[80:83], v[32:35], v[148:151], v[80:83]
    v_mfma_f32_16x16x32_bf16 v[112:115], v[32:35], v[152:155], v[112:115]
    v_mfma_f32_16x16x32_bf16 v[84:87], v[36:39], v[148:151], v[84:87]
    v_mfma_f32_16x16x32_bf16 v[116:119], v[36:39], v[152:155], v[116:119]
    v_mfma_f32_16x16x32_bf16 v[88:91], v[40:43], v[148:151], v[88:91]
    v_mfma_f32_16x16x32_bf16 v[120:123], v[40:43], v[152:155], v[120:123]
    v_mfma_f32_16x16x32_bf16 v[92:95], v[44:47], v[148:151], v[92:95]
    v_mfma_f32_16x16x32_bf16 v[124:127], v[44:47], v[152:155], v[124:127]
    v_mfma_f32_16x16x32_bf16 v[128:131], v[48:51], v[156:159], v[128:131]
    v_mfma_f32_16x16x32_bf16 v[132:135], v[52:55], v[156:159], v[132:135]
    s_waitcnt lgkmcnt(0)
    s_barrier
    v_xor_b32 v246, 64, v246
    v_xor_b32 v247, 64, v247
    v_add_u32 v228, s75, v10
    v_xor_b32 v229, 32, v228
    v_xor_b32 v230, 64, v228
    v_xor_b32 v231, 96, v228
    v_xor_b32 v232, 128, v228
    v_xor_b32 v233, 160, v228
    v_xor_b32 v234, 192, v228
    v_xor_b32 v235, 224, v228
    s_lshl_b32 s7, s60, 6
    v_xor_b32 v244, s7, v228
    v_xor_b32 v245, 32, v244
    s_add_u32 s75, s75, 8192
    s_sub_u32 s7, s75, s72
    s_cmp_eq_u32 s7, 24576
    s_cselect_b32 s75, s72, s75
    ds_read_b128 v[148:151], v246 offset:0
    ds_read_b128 v[152:155], v246 offset:2048
    ds_read_b128 v[156:159], v247 offset:16384
    ds_read_b64_tr_b16 v[16:17], v228 offset:0
    ds_read_b64_tr_b16 v[18:19], v228 offset:1024
    ds_read_b64_tr_b16 v[20:21], v229 offset:0
    ds_read_b64_tr_b16 v[22:23], v229 offset:1024
    ds_read_b64_tr_b16 v[24:25], v230 offset:0
    ds_read_b64_tr_b16 v[26:27], v230 offset:1024
    ds_read_b64_tr_b16 v[28:29], v231 offset:0
    ds_read_b64_tr_b16 v[30:31], v231 offset:1024
    ds_read_b64_tr_b16 v[32:33], v232 offset:0
    ds_read_b64_tr_b16 v[34:35], v232 offset:1024
    ds_read_b64_tr_b16 v[36:37], v233 offset:0
    ds_read_b64_tr_b16 v[38:39], v233 offset:1024
    ds_read_b64_tr_b16 v[40:41], v234 offset:0
    ds_read_b64_tr_b16 v[42:43], v234 offset:1024
    ds_read_b64_tr_b16 v[44:45], v235 offset:0
    ds_read_b64_tr_b16 v[46:47], v235 offset:1024
    ds_read_b64_tr_b16 v[48:49], v244 offset:0
    ds_read_b64_tr_b16 v[50:51], v244 offset:1024
    ds_read_b64_tr_b16 v[52:53], v245 offset:0
    ds_read_b64_tr_b16 v[54:55], v245 offset:1024
    s_mov_b32 s7, s74
    s_mov_b32 s74, s39
    s_mov_b32 s39, s7
    v_mfma_f32_16x16x32_bf16 v[64:67], v[196:199], v[136:139], v[64:67]
    v_mfma_f32_16x16x32_bf16 v[96:99], v[196:199], v[140:143], v[96:99]
    v_mfma_f32_16x16x32_bf16 v[68:71], v[200:203], v[136:139], v[68:71]
    v_mfma_f32_16x16x32_bf16 v[100:103], v[200:203], v[140:143], v[100:103]
    s_mov_b32 m0, 155648
    s_mov_b32 s68, 8192
    buffer_load_dwordx4 v6, s[52:55], s68 offen offset:0 nt lds
    v_xor_b32 v13, 128, v6
    buffer_load_dwordx4 v13, s[52:55], s68 offen offset:1024 nt lds
    v_xor_b32 v13, 16, v6
    buffer_load_dwordx4 v13, s[52:55], s68 offen offset:2048 nt lds
    v_xor_b32 v13, 144, v6
    buffer_load_dwordx4 v13, s[52:55], s68 offen offset:3072 nt lds
    v_mfma_f32_16x16x32_bf16 v[72:75], v[204:207], v[136:139], v[72:75]
    v_mfma_f32_16x16x32_bf16 v[104:107], v[204:207], v[140:143], v[104:107]
    v_mfma_f32_16x16x32_bf16 v[76:79], v[208:211], v[136:139], v[76:79]
    v_mfma_f32_16x16x32_bf16 v[108:111], v[208:211], v[140:143], v[108:111]
    v_mfma_f32_16x16x32_bf16 v[80:83], v[212:215], v[136:139], v[80:83]
    v_mfma_f32_16x16x32_bf16 v[112:115], v[212:215], v[140:143], v[112:115]
    v_mfma_f32_16x16x32_bf16 v[84:87], v[216:219], v[136:139], v[84:87]
    v_mfma_f32_16x16x32_bf16 v[116:119], v[216:219], v[140:143], v[116:119]
    v_mfma_f32_16x16x32_bf16 v[88:91], v[220:223], v[136:139], v[88:91]
    v_mfma_f32_16x16x32_bf16 v[120:123], v[220:223], v[140:143], v[120:123]
    v_mfma_f32_16x16x32_bf16 v[92:95], v[224:227], v[136:139], v[92:95]
    v_mfma_f32_16x16x32_bf16 v[124:127], v[224:227], v[140:143], v[124:127]
    v_mfma_f32_16x16x32_bf16 v[128:131], v[184:187], v[144:147], v[128:131]
    v_mfma_f32_16x16x32_bf16 v[132:135], v[188:191], v[144:147], v[132:135]
    s_waitcnt lgkmcnt(0)
    s_barrier
    v_add_u32 v247, s74, v11
    v_add_u32 v246, s61, v247
    v_add_u32 v228, s75, v10
    v_xor_b32 v229, 32, v228
    v_xor_b32 v230, 64, v228
    v_xor_b32 v231, 96, v228
    v_xor_b32 v232, 128, v228
    v_xor_b32 v233, 160, v228
    v_xor_b32 v234, 192, v228
    v_xor_b32 v235, 224, v228
    s_lshl_b32 s7, s60, 6
    v_xor_b32 v244, s7, v228
    v_xor_b32 v245, 32, v244
    s_add_u32 s75, s75, 8192
    s_sub_u32 s7, s75, s72
    s_cmp_eq_u32 s7, 24576
    s_cselect_b32 s75, s72, s75
    ds_read_b128 v[136:139], v246 offset:0
    ds_read_b128 v[140:143], v246 offset:2048
    ds_read_b128 v[144:147], v247 offset:16384
    ds_read_b64_tr_b16 v[196:197], v228 offset:0
    ds_read_b64_tr_b16 v[198:199], v228 offset:1024
    ds_read_b64_tr_b16 v[200:201], v229 offset:0
    ds_read_b64_tr_b16 v[202:203], v229 offset:1024
    ds_read_b64_tr_b16 v[204:205], v230 offset:0
    ds_read_b64_tr_b16 v[206:207], v230 offset:1024
    ds_read_b64_tr_b16 v[208:209], v231 offset:0
    ds_read_b64_tr_b16 v[210:211], v231 offset:1024
    ds_read_b64_tr_b16 v[212:213], v232 offset:0
    ds_read_b64_tr_b16 v[214:215], v232 offset:1024
    ds_read_b64_tr_b16 v[216:217], v233 offset:0
    ds_read_b64_tr_b16 v[218:219], v233 offset:1024
    ds_read_b64_tr_b16 v[220:221], v234 offset:0
    ds_read_b64_tr_b16 v[222:223], v234 offset:1024
    ds_read_b64_tr_b16 v[224:225], v235 offset:0
    ds_read_b64_tr_b16 v[226:227], v235 offset:1024
    ds_read_b64_tr_b16 v[184:185], v244 offset:0
    ds_read_b64_tr_b16 v[186:187], v244 offset:1024
    ds_read_b64_tr_b16 v[188:189], v245 offset:0
    ds_read_b64_tr_b16 v[190:191], v245 offset:1024
    v_mfma_f32_16x16x32_bf16 v[64:67], v[16:19], v[148:151], v[64:67]
    v_mfma_f32_16x16x32_bf16 v[96:99], v[16:19], v[152:155], v[96:99]
    v_mfma_f32_16x16x32_bf16 v[68:71], v[20:23], v[148:151], v[68:71]
    v_mfma_f32_16x16x32_bf16 v[100:103], v[20:23], v[152:155], v[100:103]
    s_mov_b32 m0, 159744
    s_mov_b32 s68, 12288
    buffer_load_dwordx4 v6, s[52:55], s68 offen offset:0 nt lds
    v_xor_b32 v13, 128, v6
    buffer_load_dwordx4 v13, s[52:55], s68 offen offset:1024 nt lds
    v_xor_b32 v13, 16, v6
    buffer_load_dwordx4 v13, s[52:55], s68 offen offset:2048 nt lds
    v_xor_b32 v13, 144, v6
    buffer_load_dwordx4 v13, s[52:55], s68 offen offset:3072 nt lds
    v_mfma_f32_16x16x32_bf16 v[72:75], v[24:27], v[148:151], v[72:75]
    v_mfma_f32_16x16x32_bf16 v[104:107], v[24:27], v[152:155], v[104:107]
    v_mfma_f32_16x16x32_bf16 v[76:79], v[28:31], v[148:151], v[76:79]
    v_mfma_f32_16x16x32_bf16 v[108:111], v[28:31], v[152:155], v[108:111]
    v_mfma_f32_16x16x32_bf16 v[80:83], v[32:35], v[148:151], v[80:83]
    v_mfma_f32_16x16x32_bf16 v[112:115], v[32:35], v[152:155], v[112:115]
    v_mfma_f32_16x16x32_bf16 v[84:87], v[36:39], v[148:151], v[84:87]
    v_mfma_f32_16x16x32_bf16 v[116:119], v[36:39], v[152:155], v[116:119]
    v_mfma_f32_16x16x32_bf16 v[88:91], v[40:43], v[148:151], v[88:91]
    v_mfma_f32_16x16x32_bf16 v[120:123], v[40:43], v[152:155], v[120:123]
    v_mfma_f32_16x16x32_bf16 v[92:95], v[44:47], v[148:151], v[92:95]
    v_mfma_f32_16x16x32_bf16 v[124:127], v[44:47], v[152:155], v[124:127]
    v_mfma_f32_16x16x32_bf16 v[128:131], v[48:51], v[156:159], v[128:131]
    v_mfma_f32_16x16x32_bf16 v[132:135], v[52:55], v[156:159], v[132:135]
    s_waitcnt lgkmcnt(0)
    s_barrier
    v_xor_b32 v246, 64, v246
    v_xor_b32 v247, 64, v247
    v_add_u32 v228, s75, v10
    v_xor_b32 v229, 32, v228
    v_xor_b32 v230, 64, v228
    v_xor_b32 v231, 96, v228
    v_xor_b32 v232, 128, v228
    v_xor_b32 v233, 160, v228
    v_xor_b32 v234, 192, v228
    v_xor_b32 v235, 224, v228
    s_lshl_b32 s7, s60, 6
    v_xor_b32 v244, s7, v228
    v_xor_b32 v245, 32, v244
    s_add_u32 s75, s75, 8192
    s_sub_u32 s7, s75, s72
    s_cmp_eq_u32 s7, 24576
    s_cselect_b32 s75, s72, s75
    ds_read_b128 v[148:151], v246 offset:0
    ds_read_b128 v[152:155], v246 offset:2048
    ds_read_b128 v[156:159], v247 offset:16384
    ds_read_b64_tr_b16 v[16:17], v228 offset:0
    ds_read_b64_tr_b16 v[18:19], v228 offset:1024
    ds_read_b64_tr_b16 v[20:21], v229 offset:0
    ds_read_b64_tr_b16 v[22:23], v229 offset:1024
    ds_read_b64_tr_b16 v[24:25], v230 offset:0
    ds_read_b64_tr_b16 v[26:27], v230 offset:1024
    ds_read_b64_tr_b16 v[28:29], v231 offset:0
    ds_read_b64_tr_b16 v[30:31], v231 offset:1024
    ds_read_b64_tr_b16 v[32:33], v232 offset:0
    ds_read_b64_tr_b16 v[34:35], v232 offset:1024
    ds_read_b64_tr_b16 v[36:37], v233 offset:0
    ds_read_b64_tr_b16 v[38:39], v233 offset:1024
    ds_read_b64_tr_b16 v[40:41], v234 offset:0
    ds_read_b64_tr_b16 v[42:43], v234 offset:1024
    ds_read_b64_tr_b16 v[44:45], v235 offset:0
    ds_read_b64_tr_b16 v[46:47], v235 offset:1024
    ds_read_b64_tr_b16 v[48:49], v244 offset:0
    ds_read_b64_tr_b16 v[50:51], v244 offset:1024
    ds_read_b64_tr_b16 v[52:53], v245 offset:0
    ds_read_b64_tr_b16 v[54:55], v245 offset:1024
    s_mov_b32 s7, s74
    s_mov_b32 s74, s39
    s_mov_b32 s39, s7
    v_mfma_f32_16x16x32_bf16 v[64:67], v[196:199], v[136:139], v[64:67]
    v_mfma_f32_16x16x32_bf16 v[96:99], v[196:199], v[140:143], v[96:99]
    v_mfma_f32_16x16x32_bf16 v[68:71], v[200:203], v[136:139], v[68:71]
    v_mfma_f32_16x16x32_bf16 v[100:103], v[200:203], v[140:143], v[100:103]
    v_mfma_f32_16x16x32_bf16 v[72:75], v[204:207], v[136:139], v[72:75]
    v_mfma_f32_16x16x32_bf16 v[104:107], v[204:207], v[140:143], v[104:107]
    v_mfma_f32_16x16x32_bf16 v[76:79], v[208:211], v[136:139], v[76:79]
    v_mfma_f32_16x16x32_bf16 v[108:111], v[208:211], v[140:143], v[108:111]
    v_mfma_f32_16x16x32_bf16 v[80:83], v[212:215], v[136:139], v[80:83]
    v_mfma_f32_16x16x32_bf16 v[112:115], v[212:215], v[140:143], v[112:115]
    v_mfma_f32_16x16x32_bf16 v[84:87], v[216:219], v[136:139], v[84:87]
    v_mfma_f32_16x16x32_bf16 v[116:119], v[216:219], v[140:143], v[116:119]
    v_mfma_f32_16x16x32_bf16 v[88:91], v[220:223], v[136:139], v[88:91]
    v_mfma_f32_16x16x32_bf16 v[120:123], v[220:223], v[140:143], v[120:123]
    v_mfma_f32_16x16x32_bf16 v[92:95], v[224:227], v[136:139], v[92:95]
    v_mfma_f32_16x16x32_bf16 v[124:127], v[224:227], v[140:143], v[124:127]
    v_mfma_f32_16x16x32_bf16 v[128:131], v[184:187], v[144:147], v[128:131]
    v_mfma_f32_16x16x32_bf16 v[132:135], v[188:191], v[144:147], v[132:135]
    s_waitcnt lgkmcnt(0)
    s_barrier
    v_add_u32 v247, s74, v11
    v_add_u32 v246, s61, v247
    v_add_u32 v228, s75, v10
    v_xor_b32 v229, 32, v228
    v_xor_b32 v230, 64, v228
    v_xor_b32 v231, 96, v228
    v_xor_b32 v232, 128, v228
    v_xor_b32 v233, 160, v228
    v_xor_b32 v234, 192, v228
    v_xor_b32 v235, 224, v228
    s_lshl_b32 s7, s60, 6
    v_xor_b32 v244, s7, v228
    v_xor_b32 v245, 32, v244
    s_add_u32 s75, s75, 8192
    s_sub_u32 s7, s75, s72
    s_cmp_eq_u32 s7, 24576
    s_cselect_b32 s75, s72, s75
    ds_read_b128 v[136:139], v246 offset:0
    ds_read_b128 v[140:143], v246 offset:2048
    ds_read_b128 v[144:147], v247 offset:16384
    ds_read_b64_tr_b16 v[196:197], v228 offset:0
    ds_read_b64_tr_b16 v[198:199], v228 offset:1024
    ds_read_b64_tr_b16 v[200:201], v229 offset:0
    ds_read_b64_tr_b16 v[202:203], v229 offset:1024
    ds_read_b64_tr_b16 v[204:205], v230 offset:0
    ds_read_b64_tr_b16 v[206:207], v230 offset:1024
    ds_read_b64_tr_b16 v[208:209], v231 offset:0
    ds_read_b64_tr_b16 v[210:211], v231 offset:1024
    ds_read_b64_tr_b16 v[212:213], v232 offset:0
    ds_read_b64_tr_b16 v[214:215], v232 offset:1024
    ds_read_b64_tr_b16 v[216:217], v233 offset:0
    ds_read_b64_tr_b16 v[218:219], v233 offset:1024
    ds_read_b64_tr_b16 v[220:221], v234 offset:0
    ds_read_b64_tr_b16 v[222:223], v234 offset:1024
    ds_read_b64_tr_b16 v[224:225], v235 offset:0
    ds_read_b64_tr_b16 v[226:227], v235 offset:1024
    ds_read_b64_tr_b16 v[184:185], v244 offset:0
    ds_read_b64_tr_b16 v[186:187], v244 offset:1024
    ds_read_b64_tr_b16 v[188:189], v245 offset:0
    ds_read_b64_tr_b16 v[190:191], v245 offset:1024
    v_mfma_f32_16x16x32_bf16 v[64:67], v[16:19], v[148:151], v[64:67]
    v_mfma_f32_16x16x32_bf16 v[96:99], v[16:19], v[152:155], v[96:99]
    v_mfma_f32_16x16x32_bf16 v[68:71], v[20:23], v[148:151], v[68:71]
    v_mfma_f32_16x16x32_bf16 v[100:103], v[20:23], v[152:155], v[100:103]
    v_mfma_f32_16x16x32_bf16 v[72:75], v[24:27], v[148:151], v[72:75]
    v_mfma_f32_16x16x32_bf16 v[104:107], v[24:27], v[152:155], v[104:107]
    v_mfma_f32_16x16x32_bf16 v[76:79], v[28:31], v[148:151], v[76:79]
    v_mfma_f32_16x16x32_bf16 v[108:111], v[28:31], v[152:155], v[108:111]
    v_mfma_f32_16x16x32_bf16 v[80:83], v[32:35], v[148:151], v[80:83]
    v_mfma_f32_16x16x32_bf16 v[112:115], v[32:35], v[152:155], v[112:115]
    v_mfma_f32_16x16x32_bf16 v[84:87], v[36:39], v[148:151], v[84:87]
    v_mfma_f32_16x16x32_bf16 v[116:119], v[36:39], v[152:155], v[116:119]
    v_mfma_f32_16x16x32_bf16 v[88:91], v[40:43], v[148:151], v[88:91]
    v_mfma_f32_16x16x32_bf16 v[120:123], v[40:43], v[152:155], v[120:123]
    v_mfma_f32_16x16x32_bf16 v[92:95], v[44:47], v[148:151], v[92:95]
    v_mfma_f32_16x16x32_bf16 v[124:127], v[44:47], v[152:155], v[124:127]
    v_mfma_f32_16x16x32_bf16 v[128:131], v[48:51], v[156:159], v[128:131]
    v_mfma_f32_16x16x32_bf16 v[132:135], v[52:55], v[156:159], v[132:135]
    s_waitcnt lgkmcnt(0)
    s_barrier
    v_xor_b32 v246, 64, v246
    v_xor_b32 v247, 64, v247
    v_add_u32 v228, s75, v10
    v_xor_b32 v229, 32, v228
    v_xor_b32 v230, 64, v228
    v_xor_b32 v231, 96, v228
    v_xor_b32 v232, 128, v228
    v_xor_b32 v233, 160, v228
    v_xor_b32 v234, 192, v228
    v_xor_b32 v235, 224, v228
    s_lshl_b32 s7, s60, 6
    v_xor_b32 v244, s7, v228
    v_xor_b32 v245, 32, v244
    s_add_u32 s75, s75, 8192
    s_sub_u32 s7, s75, s72
    s_cmp_eq_u32 s7, 24576
    s_cselect_b32 s75, s72, s75
    ds_read_b128 v[148:151], v246 offset:0
    ds_read_b128 v[152:155], v246 offset:2048
    ds_read_b128 v[156:159], v247 offset:16384
    ds_read_b64_tr_b16 v[16:17], v228 offset:0
    ds_read_b64_tr_b16 v[18:19], v228 offset:1024
    ds_read_b64_tr_b16 v[20:21], v229 offset:0
    ds_read_b64_tr_b16 v[22:23], v229 offset:1024
    ds_read_b64_tr_b16 v[24:25], v230 offset:0
    ds_read_b64_tr_b16 v[26:27], v230 offset:1024
    ds_read_b64_tr_b16 v[28:29], v231 offset:0
    ds_read_b64_tr_b16 v[30:31], v231 offset:1024
    ds_read_b64_tr_b16 v[32:33], v232 offset:0
    ds_read_b64_tr_b16 v[34:35], v232 offset:1024
    ds_read_b64_tr_b16 v[36:37], v233 offset:0
    ds_read_b64_tr_b16 v[38:39], v233 offset:1024
    ds_read_b64_tr_b16 v[40:41], v234 offset:0
    ds_read_b64_tr_b16 v[42:43], v234 offset:1024
    ds_read_b64_tr_b16 v[44:45], v235 offset:0
    ds_read_b64_tr_b16 v[46:47], v235 offset:1024
    ds_read_b64_tr_b16 v[48:49], v244 offset:0
    ds_read_b64_tr_b16 v[50:51], v244 offset:1024
    ds_read_b64_tr_b16 v[52:53], v245 offset:0
    ds_read_b64_tr_b16 v[54:55], v245 offset:1024
    s_mov_b32 s7, s74
    s_mov_b32 s74, s39
    s_mov_b32 s39, s7
    v_mfma_f32_16x16x32_bf16 v[64:67], v[196:199], v[136:139], v[64:67]
    v_mfma_f32_16x16x32_bf16 v[96:99], v[196:199], v[140:143], v[96:99]
    v_mfma_f32_16x16x32_bf16 v[68:71], v[200:203], v[136:139], v[68:71]
    v_mfma_f32_16x16x32_bf16 v[100:103], v[200:203], v[140:143], v[100:103]
    v_mfma_f32_16x16x32_bf16 v[72:75], v[204:207], v[136:139], v[72:75]
    v_mfma_f32_16x16x32_bf16 v[104:107], v[204:207], v[140:143], v[104:107]
    v_mfma_f32_16x16x32_bf16 v[76:79], v[208:211], v[136:139], v[76:79]
    v_mfma_f32_16x16x32_bf16 v[108:111], v[208:211], v[140:143], v[108:111]
    v_mfma_f32_16x16x32_bf16 v[80:83], v[212:215], v[136:139], v[80:83]
    v_mfma_f32_16x16x32_bf16 v[112:115], v[212:215], v[140:143], v[112:115]
    v_mfma_f32_16x16x32_bf16 v[84:87], v[216:219], v[136:139], v[84:87]
    v_mfma_f32_16x16x32_bf16 v[116:119], v[216:219], v[140:143], v[116:119]
    v_mfma_f32_16x16x32_bf16 v[88:91], v[220:223], v[136:139], v[88:91]
    v_mfma_f32_16x16x32_bf16 v[120:123], v[220:223], v[140:143], v[120:123]
    v_mfma_f32_16x16x32_bf16 v[92:95], v[224:227], v[136:139], v[92:95]
    v_mfma_f32_16x16x32_bf16 v[124:127], v[224:227], v[140:143], v[124:127]
    v_mfma_f32_16x16x32_bf16 v[128:131], v[184:187], v[144:147], v[128:131]
    v_mfma_f32_16x16x32_bf16 v[132:135], v[188:191], v[144:147], v[132:135]
    s_waitcnt lgkmcnt(0)
    s_barrier
    v_add_u32 v247, s74, v11
    v_add_u32 v246, s61, v247
    v_add_u32 v228, s75, v10
    v_xor_b32 v229, 32, v228
    v_xor_b32 v230, 64, v228
    v_xor_b32 v231, 96, v228
    v_xor_b32 v232, 128, v228
    v_xor_b32 v233, 160, v228
    v_xor_b32 v234, 192, v228
    v_xor_b32 v235, 224, v228
    s_lshl_b32 s7, s60, 6
    v_xor_b32 v244, s7, v228
    v_xor_b32 v245, 32, v244
    s_add_u32 s75, s75, 8192
    s_sub_u32 s7, s75, s72
    s_cmp_eq_u32 s7, 24576
    s_cselect_b32 s75, s72, s75
    ds_read_b128 v[136:139], v246 offset:0
    ds_read_b128 v[140:143], v246 offset:2048
    ds_read_b128 v[144:147], v247 offset:16384
    ds_read_b64_tr_b16 v[196:197], v228 offset:0
    ds_read_b64_tr_b16 v[198:199], v228 offset:1024
    ds_read_b64_tr_b16 v[200:201], v229 offset:0
    ds_read_b64_tr_b16 v[202:203], v229 offset:1024
    ds_read_b64_tr_b16 v[204:205], v230 offset:0
    ds_read_b64_tr_b16 v[206:207], v230 offset:1024
    ds_read_b64_tr_b16 v[208:209], v231 offset:0
    ds_read_b64_tr_b16 v[210:211], v231 offset:1024
    ds_read_b64_tr_b16 v[212:213], v232 offset:0
    ds_read_b64_tr_b16 v[214:215], v232 offset:1024
    ds_read_b64_tr_b16 v[216:217], v233 offset:0
    ds_read_b64_tr_b16 v[218:219], v233 offset:1024
    ds_read_b64_tr_b16 v[220:221], v234 offset:0
    ds_read_b64_tr_b16 v[222:223], v234 offset:1024
    ds_read_b64_tr_b16 v[224:225], v235 offset:0
    ds_read_b64_tr_b16 v[226:227], v235 offset:1024
    ds_read_b64_tr_b16 v[184:185], v244 offset:0
    ds_read_b64_tr_b16 v[186:187], v244 offset:1024
    ds_read_b64_tr_b16 v[188:189], v245 offset:0
    ds_read_b64_tr_b16 v[190:191], v245 offset:1024
    v_mfma_f32_16x16x32_bf16 v[64:67], v[16:19], v[148:151], v[64:67]
    v_mfma_f32_16x16x32_bf16 v[96:99], v[16:19], v[152:155], v[96:99]
    v_mfma_f32_16x16x32_bf16 v[68:71], v[20:23], v[148:151], v[68:71]
    v_mfma_f32_16x16x32_bf16 v[100:103], v[20:23], v[152:155], v[100:103]
    v_mfma_f32_16x16x32_bf16 v[72:75], v[24:27], v[148:151], v[72:75]
    v_mfma_f32_16x16x32_bf16 v[104:107], v[24:27], v[152:155], v[104:107]
    v_mfma_f32_16x16x32_bf16 v[76:79], v[28:31], v[148:151], v[76:79]
    v_mfma_f32_16x16x32_bf16 v[108:111], v[28:31], v[152:155], v[108:111]
    v_mfma_f32_16x16x32_bf16 v[80:83], v[32:35], v[148:151], v[80:83]
    v_mfma_f32_16x16x32_bf16 v[112:115], v[32:35], v[152:155], v[112:115]
    v_mfma_f32_16x16x32_bf16 v[84:87], v[36:39], v[148:151], v[84:87]
    v_mfma_f32_16x16x32_bf16 v[116:119], v[36:39], v[152:155], v[116:119]
    v_mfma_f32_16x16x32_bf16 v[88:91], v[40:43], v[148:151], v[88:91]
    v_mfma_f32_16x16x32_bf16 v[120:123], v[40:43], v[152:155], v[120:123]
    v_mfma_f32_16x16x32_bf16 v[92:95], v[44:47], v[148:151], v[92:95]
    v_mfma_f32_16x16x32_bf16 v[124:127], v[44:47], v[152:155], v[124:127]
    v_mfma_f32_16x16x32_bf16 v[128:131], v[48:51], v[156:159], v[128:131]
    v_mfma_f32_16x16x32_bf16 v[132:135], v[52:55], v[156:159], v[132:135]
    s_waitcnt vmcnt(0)
    s_waitcnt lgkmcnt(0)
L_k1_qdone:
    s_nop 7
    v_cvt_pk_bf16_f32 v16, v64, v65
    v_cvt_pk_bf16_f32 v17, v66, v67
    v_cvt_pk_bf16_f32 v18, v68, v69
    v_cvt_pk_bf16_f32 v19, v70, v71
    v_cvt_pk_bf16_f32 v20, v72, v73
    v_cvt_pk_bf16_f32 v21, v74, v75
    v_cvt_pk_bf16_f32 v22, v76, v77
    v_cvt_pk_bf16_f32 v23, v78, v79
    v_cvt_pk_bf16_f32 v24, v80, v81
    v_cvt_pk_bf16_f32 v25, v82, v83
    v_cvt_pk_bf16_f32 v26, v84, v85
    v_cvt_pk_bf16_f32 v27, v86, v87
    v_cvt_pk_bf16_f32 v28, v88, v89
    v_cvt_pk_bf16_f32 v29, v90, v91
    v_cvt_pk_bf16_f32 v30, v92, v93
    v_cvt_pk_bf16_f32 v31, v94, v95
    v_cvt_pk_bf16_f32 v32, v96, v97
    v_cvt_pk_bf16_f32 v33, v98, v99
    v_cvt_pk_bf16_f32 v34, v100, v101
    v_cvt_pk_bf16_f32 v35, v102, v103
    v_cvt_pk_bf16_f32 v36, v104, v105
    v_cvt_pk_bf16_f32 v37, v106, v107
    v_cvt_pk_bf16_f32 v38, v108, v109
    v_cvt_pk_bf16_f32 v39, v110, v111
    v_cvt_pk_bf16_f32 v40, v112, v113
    v_cvt_pk_bf16_f32 v41, v114, v115
    v_cvt_pk_bf16_f32 v42, v116, v117
    v_cvt_pk_bf16_f32 v43, v118, v119
    v_cvt_pk_bf16_f32 v44, v120, v121
    v_cvt_pk_bf16_f32 v45, v122, v123
    v_cvt_pk_bf16_f32 v46, v124, v125
    v_cvt_pk_bf16_f32 v47, v126, v127
    v_cvt_pk_bf16_f32 v242, v128, v129
    v_cvt_pk_bf16_f32 v243, v130, v131
    v_cvt_pk_bf16_f32 v244, v132, v133
    v_cvt_pk_bf16_f32 v245, v134, v135
    s_barrier
    s_add_u32 s7, s72, 0
    s_add_u32 m0, s7, s61
    s_mov_b32 s68, 16384
    buffer_load_dwordx4 v4, s[48:51], s68 offen offset:0 nt lds
    v_xor_b32 v13, 128, v4
    buffer_load_dwordx4 v13, s[48:51], s68 offen offset:1024 nt lds
    v_xor_b32 v13, 16, v4
    buffer_load_dwordx4 v13, s[48:51], s68 offen offset:2048 nt lds
    v_xor_b32 v13, 144, v4
    buffer_load_dwordx4 v13, s[48:51], s68 offen offset:3072 nt lds
    s_add_u32 s7, s72, 16384
    s_add_u32 m0, s7, s61
    s_mov_b32 s68, 16384
    buffer_load_dwordx4 v4, s[52:55], s68 offen offset:0 nt lds
    v_xor_b32 v13, 128, v4
    buffer_load_dwordx4 v13, s[52:55], s68 offen offset:1024 nt lds
    v_xor_b32 v13, 16, v4
    buffer_load_dwordx4 v13, s[52:55], s68 offen offset:2048 nt lds
    v_xor_b32 v13, 144, v4
    buffer_load_dwordx4 v13, s[52:55], s68 offen offset:3072 nt lds
    s_lshl_b32 s7, s60, 10
    s_add_u32 s7, s7, s72
    v_add_u32 v13, s7, v12
    ds_write_b128 v13, v[242:245] offset:32768
    v_add_u32 v14, s72, v12
    s_waitcnt lgkmcnt(0)
    s_barrier
    ds_read_b128 v[48:51], v14 offset:32768
    ds_read_b128 v[52:55], v14 offset:33792
    ds_read_b128 v[56:59], v14 offset:34816
    ds_read_b128 v[60:63], v14 offset:35840
    v_mov_b32 v64, 0
    v_mov_b32 v65, 0
    v_mov_b32 v66, 0
    v_mov_b32 v67, 0
    v_mov_b32 v68, 0
    v_mov_b32 v69, 0
    v_mov_b32 v70, 0
    v_mov_b32 v71, 0
    v_mov_b32 v72, 0
    v_mov_b32 v73, 0
    v_mov_b32 v74, 0
    v_mov_b32 v75, 0
    v_mov_b32 v76, 0
    v_mov_b32 v77, 0
    v_mov_b32 v78, 0
    v_mov_b32 v79, 0
    v_mov_b32 v80, 0
    v_mov_b32 v81, 0
    v_mov_b32 v82, 0
    v_mov_b32 v83, 0
    v_mov_b32 v84, 0
    v_mov_b32 v85, 0
    v_mov_b32 v86, 0
    v_mov_b32 v87, 0
    v_mov_b32 v88, 0
    v_mov_b32 v89, 0
    v_mov_b32 v90, 0
    v_mov_b32 v91, 0
    v_mov_b32 v92, 0
    v_mov_b32 v93, 0
    v_mov_b32 v94, 0
    v_mov_b32 v95, 0
    v_mov_b32 v96, 0
    v_mov_b32 v97, 0
    v_mov_b32 v98, 0
    v_mov_b32 v99, 0
    v_mov_b32 v100, 0
    v_mov_b32 v101, 0
    v_mov_b32 v102, 0
    v_mov_b32 v103, 0
    v_mov_b32 v104, 0
    v_mov_b32 v105, 0
    v_mov_b32 v106, 0
    v_mov_b32 v107, 0
    v_mov_b32 v108, 0
    v_mov_b32 v109, 0
    v_mov_b32 v110, 0
    v_mov_b32 v111, 0
    v_mov_b32 v112, 0
    v_mov_b32 v113, 0
    v_mov_b32 v114, 0
    v_mov_b32 v115, 0
    v_mov_b32 v116, 0
    v_mov_b32 v117, 0
    v_mov_b32 v118, 0
    v_mov_b32 v119, 0
    v_mov_b32 v120, 0
    v_mov_b32 v121, 0
    v_mov_b32 v122, 0
    v_mov_b32 v123, 0
    v_mov_b32 v124, 0
    v_mov_b32 v125, 0
    v_mov_b32 v126, 0
    v_mov_b32 v127, 0
    v_mov_b32 v128, 0
    v_mov_b32 v129, 0
    v_mov_b32 v130, 0
    v_mov_b32 v131, 0
    v_mov_b32 v132, 0
    v_mov_b32 v133, 0
    v_mov_b32 v134, 0
    v_mov_b32 v135, 0
    v_mov_b32 v136, 0
    v_mov_b32 v137, 0
    v_mov_b32 v138, 0
    v_mov_b32 v139, 0
    v_mov_b32 v140, 0
    v_mov_b32 v141, 0
    v_mov_b32 v142, 0
    v_mov_b32 v143, 0
    v_mov_b32 v144, 0
    v_mov_b32 v145, 0
    v_mov_b32 v146, 0
    v_mov_b32 v147, 0
    v_mov_b32 v148, 0
    v_mov_b32 v149, 0
    v_mov_b32 v150, 0
    v_mov_b32 v151, 0
    v_mov_b32 v152, 0
    v_mov_b32 v153, 0
    v_mov_b32 v154, 0
    v_mov_b32 v155, 0
    v_mov_b32 v156, 0
    v_mov_b32 v157, 0
    v_mov_b32 v158, 0
    v_mov_b32 v159, 0
    v_mov_b32 v236, 0xff800000
    v_mov_b32 v239, 0
    v_mov_b32 v237, 0xff800000
    v_mov_b32 v240, 0
    v_mov_b32 v238, 0xff800000
    v_mov_b32 v241, 0
    s_add_u32 s77, s72, 49152
    s_add_u32 s78, s72, 32768
    s_mov_b32 s79, 32768
    s_mov_b32 s67, 0x427af233
    s_waitcnt lgkmcnt(0)
    s_cmp_ge_u32 s73, 4
    s_cbranch_scc0 L_k1_st0
    s_barrier
L_k1_st0:
    s_barrier
    v_add_u32 v228, s77, v8
    v_xor_b32 v229, 32, v228
    v_xor_b32 v230, 64, v228
    v_xor_b32 v231, 96, v228
    v_xor_b32 v232, 128, v228
    v_xor_b32 v233, 160, v228
    v_xor_b32 v234, 192, v228
    v_xor_b32 v235, 224, v228
    s_add_u32 s77, s77, 16384
    s_cmp_eq_u32 s77, s97
    s_cselect_b32 s77, s72, s77
    ds_read_b64 v[196:197], v228 offset:0
    ds_read_b64 v[198:199], v229 offset:0
    ds_read_b64 v[200:201], v230 offset:0
    ds_read_b64 v[202:203], v231 offset:0
    ds_read_b64 v[204:205], v232 offset:0
    ds_read_b64 v[206:207], v233 offset:0
    ds_read_b64 v[208:209], v234 offset:0
    ds_read_b64 v[210:211], v235 offset:0
    ds_read_b64 v[212:213], v228 offset:4096
    ds_read_b64 v[214:215], v229 offset:4096
    ds_read_b64 v[216:217], v230 offset:4096
    ds_read_b64 v[218:219], v231 offset:4096
    s_waitcnt lgkmcnt(10)
    v_mfma_f32_16x16x32_bf16 v[160:163], v[196:199], v[16:19], 0
    v_mfma_f32_16x16x32_bf16 v[176:179], v[196:199], v[32:35], 0
    ds_read_b64 v[220:221], v232 offset:4096
    ds_read_b64 v[222:223], v233 offset:4096
    s_waitcnt lgkmcnt(10)
    v_mfma_f32_16x16x32_bf16 v[160:163], v[200:203], v[20:23], v[160:163]
    v_mfma_f32_16x16x32_bf16 v[176:179], v[200:203], v[36:39], v[176:179]
    ds_read_b64 v[224:225], v234 offset:4096
    ds_read_b64 v[226:227], v235 offset:4096
    s_waitcnt lgkmcnt(10)
    v_mfma_f32_16x16x32_bf16 v[160:163], v[204:207], v[24:27], v[160:163]
    v_mfma_f32_16x16x32_bf16 v[176:179], v[204:207], v[40:43], v[176:179]
    ds_read_b64 v[196:197], v228 offset:8192
    ds_read_b64 v[198:199], v229 offset:8192
    s_waitcnt lgkmcnt(10)
    v_mfma_f32_16x16x32_bf16 v[160:163], v[208:211], v[28:31], v[160:163]
    v_mfma_f32_16x16x32_bf16 v[176:179], v[208:211], v[44:47], v[176:179]
    ds_read_b64 v[200:201], v230 offset:8192
    ds_read_b64 v[202:203], v231 offset:8192
    s_waitcnt lgkmcnt(10)
    v_mfma_f32_16x16x32_bf16 v[164:167], v[212:215], v[16:19], 0
    v_mfma_f32_16x16x32_bf16 v[180:183], v[212:215], v[32:35], 0
    ds_read_b64 v[204:205], v232 offset:8192
    ds_read_b64 v[206:207], v233 offset:8192
    s_waitcnt lgkmcnt(10)
    v_mfma_f32_16x16x32_bf16 v[164:167], v[216:219], v[20:23], v[164:167]
    v_mfma_f32_16x16x32_bf16 v[180:183], v[216:219], v[36:39], v[180:183]
    ds_read_b64 v[208:209], v234 offset:8192
    ds_read_b64 v[210:211], v235 offset:8192
    s_waitcnt lgkmcnt(10)
    v_mfma_f32_16x16x32_bf16 v[164:167], v[220:223], v[24:27], v[164:167]
    v_mfma_f32_16x16x32_bf16 v[180:183], v[220:223], v[40:43], v[180:183]
    ds_read_b64 v[212:213], v228 offset:12288
    ds_read_b64 v[214:215], v229 offset:12288
    s_waitcnt lgkmcnt(10)
    v_mfma_f32_16x16x32_bf16 v[164:167], v[224:227], v[28:31], v[164:167]
    v_mfma_f32_16x16x32_bf16 v[180:183], v[224:227], v[44:47], v[180:183]
    ds_read_b64 v[216:217], v230 offset:12288
    ds_read_b64 v[218:219], v231 offset:12288
    s_waitcnt lgkmcnt(10)
    v_mfma_f32_16x16x32_bf16 v[168:171], v[196:199], v[16:19], 0
    v_mfma_f32_16x16x32_bf16 v[184:187], v[196:199], v[32:35], 0
    ds_read_b64 v[220:221], v232 offset:12288
    ds_read_b64 v[222:223], v233 offset:12288
    s_waitcnt lgkmcnt(10)
    v_mfma_f32_16x16x32_bf16 v[168:171], v[200:203], v[20:23], v[168:171]
    v_mfma_f32_16x16x32_bf16 v[184:187], v[200:203], v[36:39], v[184:187]
    ds_read_b64 v[224:225], v234 offset:12288
    ds_read_b64 v[226:227], v235 offset:12288
    s_waitcnt lgkmcnt(10)
    v_mfma_f32_16x16x32_bf16 v[168:171], v[204:207], v[24:27], v[168:171]
    v_mfma_f32_16x16x32_bf16 v[184:187], v[204:207], v[40:43], v[184:187]
    v_add_u32 v242, s61, v228
    ds_read_b64 v[196:197], v242
    v_add_u32 v243, s61, v229
    ds_read_b64 v[198:199], v243
    s_waitcnt lgkmcnt(10)
    v_mfma_f32_16x16x32_bf16 v[168:171], v[208:211], v[28:31], v[168:171]
    v_mfma_f32_16x16x32_bf16 v[184:187], v[208:211], v[44:47], v[184:187]
    v_add_u32 v242, s61, v230
    ds_read_b64 v[200:201], v242
    v_add_u32 v243, s61, v231
    ds_read_b64 v[202:203], v243
    s_waitcnt lgkmcnt(10)
    v_mfma_f32_16x16x32_bf16 v[172:175], v[212:215], v[16:19], 0
    v_mfma_f32_16x16x32_bf16 v[188:191], v[212:215], v[32:35], 0
    v_add_u32 v242, s61, v232
    ds_read_b64 v[204:205], v242
    v_add_u32 v243, s61, v233
    ds_read_b64 v[206:207], v243
    s_waitcnt lgkmcnt(10)
    v_mfma_f32_16x16x32_bf16 v[172:175], v[216:219], v[20:23], v[172:175]
    v_mfma_f32_16x16x32_bf16 v[188:191], v[216:219], v[36:39], v[188:191]
    v_add_u32 v242, s61, v234
    ds_read_b64 v[208:209], v242
    v_add_u32 v243, s61, v235
    ds_read_b64 v[210:211], v243
    s_waitcnt lgkmcnt(10)
    v_mfma_f32_16x16x32_bf16 v[172:175], v[220:223], v[24:27], v[172:175]
    v_mfma_f32_16x16x32_bf16 v[188:191], v[220:223], v[40:43], v[188:191]
    s_waitcnt lgkmcnt(8)
    v_mfma_f32_16x16x32_bf16 v[172:175], v[224:227], v[28:31], v[172:175]
    v_mfma_f32_16x16x32_bf16 v[188:191], v[224:227], v[44:47], v[188:191]
    s_waitcnt lgkmcnt(6)
    v_mfma_f32_16x16x32_bf16 v[192:195], v[196:199], v[48:51], 0
    s_waitcnt lgkmcnt(4)
    v_mfma_f32_16x16x32_bf16 v[192:195], v[200:203], v[52:55], v[192:195]
    s_waitcnt lgkmcnt(2)
    v_mfma_f32_16x16x32_bf16 v[192:195], v[204:207], v[56:59], v[192:195]
    s_waitcnt lgkmcnt(0)
    v_mfma_f32_16x16x32_bf16 v[192:195], v[208:211], v[60:63], v[192:195]
    s_barrier
    v_max3_f32 v250, v160, v161, v162
    v_max3_f32 v250, v250, v163, v164
    v_max3_f32 v250, v250, v165, v166
    v_max3_f32 v250, v250, v167, v168
    v_max3_f32 v250, v250, v169, v170
    v_max3_f32 v250, v250, v171, v172
    v_max3_f32 v250, v250, v173, v174
    v_max_f32 v250, v250, v175
    v_max3_f32 v251, v176, v177, v178
    v_max3_f32 v251, v251, v179, v180
    v_max3_f32 v251, v251, v181, v182
    v_max3_f32 v251, v251, v183, v184
    v_max3_f32 v251, v251, v185, v186
    v_max3_f32 v251, v251, v187, v188
    v_max3_f32 v251, v251, v189, v190
    v_max_f32 v251, v251, v191
    v_max3_f32 v252, v192, v193, v194
    v_max_f32 v252, v252, v195
    v_mov_b32 v253, v250
    s_nop 1
    v_permlane32_swap_b32 v250, v253
    v_max_f32 v250, v250, v253
    v_mov_b32 v253, v250
    s_nop 1
    v_permlane16_swap_b32 v250, v253
    v_max_f32 v250, v250, v253
    v_mov_b32 v254, v251
    s_nop 1
    v_permlane32_swap_b32 v251, v254
    v_max_f32 v251, v251, v254
    v_mov_b32 v254, v251
    s_nop 1
    v_permlane16_swap_b32 v251, v254
    v_max_f32 v251, v251, v254
    v_mov_b32 v253, v252
    s_nop 1
    v_permlane32_swap_b32 v252, v253
    v_max_f32 v252, v252, v253
    v_mov_b32 v253, v252
    s_nop 1
    v_permlane16_swap_b32 v252, v253
    v_max_f32 v252, v252, v253
    v_sub_f32 v244, v250, v236
    v_sub_f32 v245, v251, v237
    v_sub_f32 v246, v252, v238
    v_max3_f32 v253, v244, v245, v246
    v_cmp_lt_f32 vcc, s67, v253
    s_nop 4
    s_cbranch_vccz L_k1_nors1
    v_max_f32 v250, v250, v236
    v_sub_f32 v244, v236, v250
    v_mul_f32 v244, s62, v244
    v_exp_f32 v244, v244
    v_mov_b32 v236, v250
    v_max_f32 v251, v251, v237
    v_sub_f32 v245, v237, v251
    v_mul_f32 v245, s62, v245
    v_exp_f32 v245, v245
    v_mov_b32 v237, v251
    v_max_f32 v252, v252, v238
    v_sub_f32 v246, v238, v252
    v_mul_f32 v246, s62, v246
    v_exp_f32 v246, v246
    v_mov_b32 v238, v252
    v_mul_f32 v239, v239, v244
    v_mul_f32 v64, v64, v244
    v_mul_f32 v65, v65, v244
    v_mul_f32 v66, v66, v244
    v_mul_f32 v67, v67, v244
    v_mul_f32 v68, v68, v244
    v_mul_f32 v69, v69, v244
    v_mul_f32 v70, v70, v244
    v_mul_f32 v71, v71, v244
    v_mul_f32 v72, v72, v244
    v_mul_f32 v73, v73, v244
    v_mul_f32 v74, v74, v244
    v_mul_f32 v75, v75, v244
    v_mul_f32 v76, v76, v244
    v_mul_f32 v77, v77, v244
    v_mul_f32 v78, v78, v244
    v_mul_f32 v79, v79, v244
    v_mul_f32 v80, v80, v244
    v_mul_f32 v81, v81, v244
    v_mul_f32 v82, v82, v244
    v_mul_f32 v83, v83, v244
    v_mul_f32 v84, v84, v244
    v_mul_f32 v85, v85, v244
    v_mul_f32 v86, v86, v244
    v_mul_f32 v87, v87, v244
    v_mul_f32 v88, v88, v244
    v_mul_f32 v89, v89, v244
    v_mul_f32 v90, v90, v244
    v_mul_f32 v91, v91, v244
    v_mul_f32 v92, v92, v244
    v_mul_f32 v93, v93, v244
    v_mul_f32 v94, v94, v244
    v_mul_f32 v95, v95, v244
    v_mul_f32 v240, v240, v245
    v_mul_f32 v96, v96, v245
    v_mul_f32 v97, v97, v245
    v_mul_f32 v98, v98, v245
    v_mul_f32 v99, v99, v245
    v_mul_f32 v100, v100, v245
    v_mul_f32 v101, v101, v245
    v_mul_f32 v102, v102, v245
    v_mul_f32 v103, v103, v245
    v_mul_f32 v104, v104, v245
    v_mul_f32 v105, v105, v245
    v_mul_f32 v106, v106, v245
    v_mul_f32 v107, v107, v245
    v_mul_f32 v108, v108, v245
    v_mul_f32 v109, v109, v245
    v_mul_f32 v110, v110, v245
    v_mul_f32 v111, v111, v245
    v_mul_f32 v112, v112, v245
    v_mul_f32 v113, v113, v245
    v_mul_f32 v114, v114, v245
    v_mul_f32 v115, v115, v245
    v_mul_f32 v116, v116, v245
    v_mul_f32 v117, v117, v245
    v_mul_f32 v118, v118, v245
    v_mul_f32 v119, v119, v245
    v_mul_f32 v120, v120, v245
    v_mul_f32 v121, v121, v245
    v_mul_f32 v122, v122, v245
    v_mul_f32 v123, v123, v245
    v_mul_f32 v124, v124, v245
    v_mul_f32 v125, v125, v245
    v_mul_f32 v126, v126, v245
    v_mul_f32 v127, v127, v245
    v_mul_f32 v241, v241, v246
    v_mul_f32 v128, v128, v246
    v_mul_f32 v129, v129, v246
    v_mul_f32 v130, v130, v246
    v_mul_f32 v131, v131, v246
    v_mul_f32 v132, v132, v246
    v_mul_f32 v133, v133, v246
    v_mul_f32 v134, v134, v246
    v_mul_f32 v135, v135, v246
    v_mul_f32 v136, v136, v246
    v_mul_f32 v137, v137, v246
    v_mul_f32 v138, v138, v246
    v_mul_f32 v139, v139, v246
    v_mul_f32 v140, v140, v246
    v_mul_f32 v141, v141, v246
    v_mul_f32 v142, v142, v246
    v_mul_f32 v143, v143, v246
    v_mul_f32 v144, v144, v246
    v_mul_f32 v145, v145, v246
    v_mul_f32 v146, v146, v246
    v_mul_f32 v147, v147, v246
    v_mul_f32 v148, v148, v246
    v_mul_f32 v149, v149, v246
    v_mul_f32 v150, v150, v246
    v_mul_f32 v151, v151, v246
    v_mul_f32 v152, v152, v246
    v_mul_f32 v153, v153, v246
    v_mul_f32 v154, v154, v246
    v_mul_f32 v155, v155, v246
    v_mul_f32 v156, v156, v246
    v_mul_f32 v157, v157, v246
    v_mul_f32 v158, v158, v246
    v_mul_f32 v159, v159, v246
L_k1_nors1:
    s_nop 1
    v_mul_f32 v247, s62, v236
    v_mul_f32 v248, s62, v237
    v_mul_f32 v249, s62, v238
    v_fma_f32 v160, v160, s62, -v247
    v_fma_f32 v161, v161, s62, -v247
    v_fma_f32 v162, v162, s62, -v247
    v_fma_f32 v163, v163, s62, -v247
    v_fma_f32 v164, v164, s62, -v247
    v_fma_f32 v165, v165, s62, -v247
    v_fma_f32 v166, v166, s62, -v247
    v_fma_f32 v167, v167, s62, -v247
    v_fma_f32 v168, v168, s62, -v247
    v_fma_f32 v169, v169, s62, -v247
    v_fma_f32 v170, v170, s62, -v247
    v_fma_f32 v171, v171, s62, -v247
    v_fma_f32 v172, v172, s62, -v247
    v_fma_f32 v173, v173, s62, -v247
    v_fma_f32 v174, v174, s62, -v247
    v_fma_f32 v175, v175, s62, -v247
    v_exp_f32 v160, v160
    v_exp_f32 v161, v161
    v_exp_f32 v162, v162
    v_exp_f32 v163, v163
    v_exp_f32 v164, v164
    v_exp_f32 v165, v165
    v_exp_f32 v166, v166
    v_exp_f32 v167, v167
    v_exp_f32 v168, v168
    v_exp_f32 v169, v169
    v_exp_f32 v170, v170
    v_exp_f32 v171, v171
    v_exp_f32 v172, v172
    v_exp_f32 v173, v173
    v_exp_f32 v174, v174
    v_exp_f32 v175, v175
    v_add_f32 v239, v239, v160
    v_add_f32 v239, v239, v161
    v_add_f32 v239, v239, v162
    v_add_f32 v239, v239, v163
    v_add_f32 v239, v239, v164
    v_add_f32 v239, v239, v165
    v_add_f32 v239, v239, v166
    v_add_f32 v239, v239, v167
    v_add_f32 v239, v239, v168
    v_add_f32 v239, v239, v169
    v_add_f32 v239, v239, v170
    v_add_f32 v239, v239, v171
    v_add_f32 v239, v239, v172
    v_add_f32 v239, v239, v173
    v_add_f32 v239, v239, v174
    v_add_f32 v239, v239, v175
    v_cvt_pk_bf16_f32 v160, v160, v161
    v_cvt_pk_bf16_f32 v161, v162, v163
    v_cvt_pk_bf16_f32 v162, v164, v165
    v_cvt_pk_bf16_f32 v163, v166, v167
    v_cvt_pk_bf16_f32 v168, v168, v169
    v_cvt_pk_bf16_f32 v169, v170, v171
    v_cvt_pk_bf16_f32 v170, v172, v173
    v_cvt_pk_bf16_f32 v171, v174, v175
    v_fma_f32 v176, v176, s62, -v248
    v_fma_f32 v177, v177, s62, -v248
    v_fma_f32 v178, v178, s62, -v248
    v_fma_f32 v179, v179, s62, -v248
    v_fma_f32 v180, v180, s62, -v248
    v_fma_f32 v181, v181, s62, -v248
    v_fma_f32 v182, v182, s62, -v248
    v_fma_f32 v183, v183, s62, -v248
    v_fma_f32 v184, v184, s62, -v248
    v_fma_f32 v185, v185, s62, -v248
    v_fma_f32 v186, v186, s62, -v248
    v_fma_f32 v187, v187, s62, -v248
    v_fma_f32 v188, v188, s62, -v248
    v_fma_f32 v189, v189, s62, -v248
    v_fma_f32 v190, v190, s62, -v248
    v_fma_f32 v191, v191, s62, -v248
    v_exp_f32 v176, v176
    v_exp_f32 v177, v177
    v_exp_f32 v178, v178
    v_exp_f32 v179, v179
    v_exp_f32 v180, v180
    v_exp_f32 v181, v181
    v_exp_f32 v182, v182
    v_exp_f32 v183, v183
    v_exp_f32 v184, v184
    v_exp_f32 v185, v185
    v_exp_f32 v186, v186
    v_exp_f32 v187, v187
    v_exp_f32 v188, v188
    v_exp_f32 v189, v189
    v_exp_f32 v190, v190
    v_exp_f32 v191, v191
    v_add_f32 v240, v240, v176
    v_add_f32 v240, v240, v177
    v_add_f32 v240, v240, v178
    v_add_f32 v240, v240, v179
    v_add_f32 v240, v240, v180
    v_add_f32 v240, v240, v181
    v_add_f32 v240, v240, v182
    v_add_f32 v240, v240, v183
    v_add_f32 v240, v240, v184
    v_add_f32 v240, v240, v185
    v_add_f32 v240, v240, v186
    v_add_f32 v240, v240, v187
    v_add_f32 v240, v240, v188
    v_add_f32 v240, v240, v189
    v_add_f32 v240, v240, v190
    v_add_f32 v240, v240, v191
    v_cvt_pk_bf16_f32 v176, v176, v177
    v_cvt_pk_bf16_f32 v177, v178, v179
    v_cvt_pk_bf16_f32 v178, v180, v181
    v_cvt_pk_bf16_f32 v179, v182, v183
    v_cvt_pk_bf16_f32 v184, v184, v185
    v_cvt_pk_bf16_f32 v185, v186, v187
    v_cvt_pk_bf16_f32 v186, v188, v189
    v_cvt_pk_bf16_f32 v187, v190, v191
    v_fma_f32 v192, v192, s62, -v249
    v_fma_f32 v193, v193, s62, -v249
    v_fma_f32 v194, v194, s62, -v249
    v_fma_f32 v195, v195, s62, -v249
    v_exp_f32 v192, v192
    v_exp_f32 v193, v193
    v_exp_f32 v194, v194
    v_exp_f32 v195, v195
    v_add_f32 v241, v241, v192
    v_add_f32 v241, v241, v193
    v_add_f32 v241, v241, v194
    v_add_f32 v241, v241, v195
    v_cvt_pk_bf16_f32 v192, v192, v193
    v_cvt_pk_bf16_f32 v193, v194, v195
    s_mov_b32 s63, 7
    s_nop 7
L_k1_attn:
    s_waitcnt vmcnt(8)
    s_waitcnt vmcnt(4)
    s_barrier
    s_add_u32 m0, s78, s61
    s_nop 0
    buffer_load_dwordx4 v4, s[48:51], s79 offen offset:0 nt lds
    v_xor_b32 v13, 128, v4
    buffer_load_dwordx4 v13, s[48:51], s79 offen offset:1024 nt lds
    v_xor_b32 v13, 16, v4
    buffer_load_dwordx4 v13, s[48:51], s79 offen offset:2048 nt lds
    v_xor_b32 v13, 144, v4
    buffer_load_dwordx4 v13, s[48:51], s79 offen offset:3072 nt lds
    s_add_u32 s78, s78, 16384
    s_cmp_eq_u32 s78, s97
    s_cselect_b32 s78, s72, s78
    s_add_u32 m0, s78, s61
    s_nop 0
    buffer_load_dwordx4 v4, s[52:55], s79 offen offset:0 nt lds
    v_xor_b32 v13, 128, v4
    buffer_load_dwordx4 v13, s[52:55], s79 offen offset:1024 nt lds
    v_xor_b32 v13, 16, v4
    buffer_load_dwordx4 v13, s[52:55], s79 offen offset:2048 nt lds
    v_xor_b32 v13, 144, v4
    buffer_load_dwordx4 v13, s[52:55], s79 offen offset:3072 nt lds
    s_add_u32 s78, s78, 16384
    s_cmp_eq_u32 s78, s97
    s_cselect_b32 s78, s72, s78
    s_add_u32 s79, s79, 16384
    v_add_u32 v228, s77, v9
    v_xor_b32 v229, 32, v228
    v_xor_b32 v230, 64, v228
    v_xor_b32 v231, 96, v228
    v_xor_b32 v232, 128, v228
    v_xor_b32 v233, 160, v228
    v_xor_b32 v234, 192, v228
    v_xor_b32 v235, 224, v228
    s_add_u32 s77, s77, 16384
    s_cmp_eq_u32 s77, s97
    s_cselect_b32 s77, s72, s77
    ds_read_b64_tr_b16 v[196:197], v228 offset:0
    ds_read_b64_tr_b16 v[198:199], v228 offset:4096
    ds_read_b64_tr_b16 v[200:201], v229 offset:0
    ds_read_b64_tr_b16 v[202:203], v229 offset:4096
    ds_read_b64_tr_b16 v[204:205], v230 offset:0
    ds_read_b64_tr_b16 v[206:207], v230 offset:4096
    ds_read_b64_tr_b16 v[208:209], v231 offset:0
    ds_read_b64_tr_b16 v[210:211], v231 offset:4096
    ds_read_b64_tr_b16 v[212:213], v232 offset:0
    ds_read_b64_tr_b16 v[214:215], v232 offset:4096
    ds_read_b64_tr_b16 v[216:217], v233 offset:0
    ds_read_b64_tr_b16 v[218:219], v233 offset:4096
    s_waitcnt lgkmcnt(10)
    v_mfma_f32_16x16x32_bf16 v[64:67], v[196:199], v[160:163], v[64:67]
    v_mfma_f32_16x16x32_bf16 v[96:99], v[196:199], v[176:179], v[96:99]
    ds_read_b64_tr_b16 v[220:221], v234 offset:0
    ds_read_b64_tr_b16 v[222:223], v234 offset:4096
    s_waitcnt lgkmcnt(10)
    v_mfma_f32_16x16x32_bf16 v[68:71], v[200:203], v[160:163], v[68:71]
    v_mfma_f32_16x16x32_bf16 v[100:103], v[200:203], v[176:179], v[100:103]
    ds_read_b64_tr_b16 v[224:225], v235 offset:0
    ds_read_b64_tr_b16 v[226:227], v235 offset:4096
    s_waitcnt lgkmcnt(10)
    v_mfma_f32_16x16x32_bf16 v[72:75], v[204:207], v[160:163], v[72:75]
    v_mfma_f32_16x16x32_bf16 v[104:107], v[204:207], v[176:179], v[104:107]
    ds_read_b64_tr_b16 v[196:197], v228 offset:8192
    ds_read_b64_tr_b16 v[198:199], v228 offset:12288
    s_waitcnt lgkmcnt(10)
    v_mfma_f32_16x16x32_bf16 v[76:79], v[208:211], v[160:163], v[76:79]
    v_mfma_f32_16x16x32_bf16 v[108:111], v[208:211], v[176:179], v[108:111]
    ds_read_b64_tr_b16 v[200:201], v229 offset:8192
    ds_read_b64_tr_b16 v[202:203], v229 offset:12288
    s_waitcnt lgkmcnt(10)
    v_mfma_f32_16x16x32_bf16 v[80:83], v[212:215], v[160:163], v[80:83]
    v_mfma_f32_16x16x32_bf16 v[112:115], v[212:215], v[176:179], v[112:115]
    ds_read_b64_tr_b16 v[204:205], v230 offset:8192
    ds_read_b64_tr_b16 v[206:207], v230 offset:12288
    s_waitcnt lgkmcnt(10)
    v_mfma_f32_16x16x32_bf16 v[84:87], v[216:219], v[160:163], v[84:87]
    v_mfma_f32_16x16x32_bf16 v[116:119], v[216:219], v[176:179], v[116:119]
    ds_read_b64_tr_b16 v[208:209], v231 offset:8192
    ds_read_b64_tr_b16 v[210:211], v231 offset:12288
    s_waitcnt lgkmcnt(10)
    v_mfma_f32_16x16x32_bf16 v[88:91], v[220:223], v[160:163], v[88:91]
    v_mfma_f32_16x16x32_bf16 v[120:123], v[220:223], v[176:179], v[120:123]
    ds_read_b64_tr_b16 v[212:213], v232 offset:8192
    ds_read_b64_tr_b16 v[214:215], v232 offset:12288
    s_waitcnt lgkmcnt(10)
    v_mfma_f32_16x16x32_bf16 v[92:95], v[224:227], v[160:163], v[92:95]
    v_mfma_f32_16x16x32_bf16 v[124:127], v[224:227], v[176:179], v[124:127]
    ds_read_b64_tr_b16 v[216:217], v233 offset:8192
    ds_read_b64_tr_b16 v[218:219], v233 offset:12288
    s_waitcnt lgkmcnt(10)
    v_mfma_f32_16x16x32_bf16 v[64:67], v[196:199], v[168:171], v[64:67]
    v_mfma_f32_16x16x32_bf16 v[96:99], v[196:199], v[184:187], v[96:99]
    ds_read_b64_tr_b16 v[220:221], v234 offset:8192
    ds_read_b64_tr_b16 v[222:223], v234 offset:12288
    s_waitcnt lgkmcnt(10)
    v_mfma_f32_16x16x32_bf16 v[68:71], v[200:203], v[168:171], v[68:71]
    v_mfma_f32_16x16x32_bf16 v[100:103], v[200:203], v[184:187], v[100:103]
    ds_read_b64_tr_b16 v[224:225], v235 offset:8192
    ds_read_b64_tr_b16 v[226:227], v235 offset:12288
    s_waitcnt lgkmcnt(10)
    v_mfma_f32_16x16x32_bf16 v[72:75], v[204:207], v[168:171], v[72:75]
    v_mfma_f32_16x16x32_bf16 v[104:107], v[204:207], v[184:187], v[104:107]
    v_add_u32 v242, s61, v228
    ds_read_b64_tr_b16 v[196:197], v242
    v_add_u32 v243, s61, v229
    ds_read_b64_tr_b16 v[198:199], v243
    s_waitcnt lgkmcnt(10)
    v_mfma_f32_16x16x32_bf16 v[76:79], v[208:211], v[168:171], v[76:79]
    v_mfma_f32_16x16x32_bf16 v[108:111], v[208:211], v[184:187], v[108:111]
    v_add_u32 v242, s61, v230
    ds_read_b64_tr_b16 v[200:201], v242
    v_add_u32 v243, s61, v231
    ds_read_b64_tr_b16 v[202:203], v243
    s_waitcnt lgkmcnt(10)
    v_mfma_f32_16x16x32_bf16 v[80:83], v[212:215], v[168:171], v[80:83]
    v_mfma_f32_16x16x32_bf16 v[112:115], v[212:215], v[184:187], v[112:115]
    v_add_u32 v242, s61, v232
    ds_read_b64_tr_b16 v[204:205], v242
    v_add_u32 v243, s61, v233
    ds_read_b64_tr_b16 v[206:207], v243
    s_waitcnt lgkmcnt(10)
    v_mfma_f32_16x16x32_bf16 v[84:87], v[216:219], v[168:171], v[84:87]
    v_mfma_f32_16x16x32_bf16 v[116:119], v[216:219], v[184:187], v[116:119]
    v_add_u32 v242, s61, v234
    ds_read_b64_tr_b16 v[208:209], v242
    v_add_u32 v243, s61, v235
    ds_read_b64_tr_b16 v[210:211], v243
    s_waitcnt lgkmcnt(10)
    v_mfma_f32_16x16x32_bf16 v[88:91], v[220:223], v[168:171], v[88:91]
    v_mfma_f32_16x16x32_bf16 v[120:123], v[220:223], v[184:187], v[120:123]
    s_waitcnt lgkmcnt(8)
    v_mfma_f32_16x16x32_bf16 v[92:95], v[224:227], v[168:171], v[92:95]
    v_mfma_f32_16x16x32_bf16 v[124:127], v[224:227], v[184:187], v[124:127]
    s_waitcnt lgkmcnt(7)
    v_mfma_f32_16x16x16_bf16 v[128:131], v[196:197], v[192:193], v[128:131]
    s_waitcnt lgkmcnt(6)
    v_mfma_f32_16x16x16_bf16 v[132:135], v[198:199], v[192:193], v[132:135]
    s_waitcnt lgkmcnt(5)
    v_mfma_f32_16x16x16_bf16 v[136:139], v[200:201], v[192:193], v[136:139]
    s_waitcnt lgkmcnt(4)
    v_mfma_f32_16x16x16_bf16 v[140:143], v[202:203], v[192:193], v[140:143]
    s_waitcnt lgkmcnt(3)
    v_mfma_f32_16x16x16_bf16 v[144:147], v[204:205], v[192:193], v[144:147]
    s_waitcnt lgkmcnt(2)
    v_mfma_f32_16x16x16_bf16 v[148:151], v[206:207], v[192:193], v[148:151]
    s_waitcnt lgkmcnt(1)
    v_mfma_f32_16x16x16_bf16 v[152:155], v[208:209], v[192:193], v[152:155]
    s_waitcnt lgkmcnt(0)
    v_mfma_f32_16x16x16_bf16 v[156:159], v[210:211], v[192:193], v[156:159]
    v_add_u32 v228, s77, v8
    v_xor_b32 v229, 32, v228
    v_xor_b32 v230, 64, v228
    v_xor_b32 v231, 96, v228
    v_xor_b32 v232, 128, v228
    v_xor_b32 v233, 160, v228
    v_xor_b32 v234, 192, v228
    v_xor_b32 v235, 224, v228
    s_add_u32 s77, s77, 16384
    s_cmp_eq_u32 s77, s97
    s_cselect_b32 s77, s72, s77
    ds_read_b64 v[212:213], v228 offset:0
    ds_read_b64 v[214:215], v229 offset:0
    ds_read_b64 v[216:217], v230 offset:0
    ds_read_b64 v[218:219], v231 offset:0
    ds_read_b64 v[220:221], v232 offset:0
    ds_read_b64 v[222:223], v233 offset:0
    ds_read_b64 v[224:225], v234 offset:0
    ds_read_b64 v[226:227], v235 offset:0
    ds_read_b64 v[196:197], v228 offset:4096
    ds_read_b64 v[198:199], v229 offset:4096
    ds_read_b64 v[200:201], v230 offset:4096
    ds_read_b64 v[202:203], v231 offset:4096
    s_waitcnt lgkmcnt(10)
    v_mfma_f32_16x16x32_bf16 v[160:163], v[212:215], v[16:19], 0
    v_mfma_f32_16x16x32_bf16 v[176:179], v[212:215], v[32:35], 0
    ds_read_b64 v[204:205], v232 offset:4096
    ds_read_b64 v[206:207], v233 offset:4096
    s_waitcnt lgkmcnt(10)
    v_mfma_f32_16x16x32_bf16 v[160:163], v[216:219], v[20:23], v[160:163]
    v_mfma_f32_16x16x32_bf16 v[176:179], v[216:219], v[36:39], v[176:179]
    ds_read_b64 v[208:209], v234 offset:4096
    ds_read_b64 v[210:211], v235 offset:4096
    s_waitcnt lgkmcnt(10)
    v_mfma_f32_16x16x32_bf16 v[160:163], v[220:223], v[24:27], v[160:163]
    v_mfma_f32_16x16x32_bf16 v[176:179], v[220:223], v[40:43], v[176:179]
    ds_read_b64 v[212:213], v228 offset:8192
    ds_read_b64 v[214:215], v229 offset:8192
    s_waitcnt lgkmcnt(10)
    v_mfma_f32_16x16x32_bf16 v[160:163], v[224:227], v[28:31], v[160:163]
    v_mfma_f32_16x16x32_bf16 v[176:179], v[224:227], v[44:47], v[176:179]
    ds_read_b64 v[216:217], v230 offset:8192
    ds_read_b64 v[218:219], v231 offset:8192
    s_waitcnt lgkmcnt(10)
    v_mfma_f32_16x16x32_bf16 v[164:167], v[196:199], v[16:19], 0
    v_mfma_f32_16x16x32_bf16 v[180:183], v[196:199], v[32:35], 0
    ds_read_b64 v[220:221], v232 offset:8192
    ds_read_b64 v[222:223], v233 offset:8192
    s_waitcnt lgkmcnt(10)
    v_mfma_f32_16x16x32_bf16 v[164:167], v[200:203], v[20:23], v[164:167]
    v_mfma_f32_16x16x32_bf16 v[180:183], v[200:203], v[36:39], v[180:183]
    ds_read_b64 v[224:225], v234 offset:8192
    ds_read_b64 v[226:227], v235 offset:8192
    s_waitcnt lgkmcnt(10)
    v_mfma_f32_16x16x32_bf16 v[164:167], v[204:207], v[24:27], v[164:167]
    v_mfma_f32_16x16x32_bf16 v[180:183], v[204:207], v[40:43], v[180:183]
    ds_read_b64 v[196:197], v228 offset:12288
    ds_read_b64 v[198:199], v229 offset:12288
    s_waitcnt lgkmcnt(10)
    v_mfma_f32_16x16x32_bf16 v[164:167], v[208:211], v[28:31], v[164:167]
    v_mfma_f32_16x16x32_bf16 v[180:183], v[208:211], v[44:47], v[180:183]
    ds_read_b64 v[200:201], v230 offset:12288
    ds_read_b64 v[202:203], v231 offset:12288
    s_waitcnt lgkmcnt(10)
    v_mfma_f32_16x16x32_bf16 v[168:171], v[212:215], v[16:19], 0
    v_mfma_f32_16x16x32_bf16 v[184:187], v[212:215], v[32:35], 0
    ds_read_b64 v[204:205], v232 offset:12288
    ds_read_b64 v[206:207], v233 offset:12288
    s_waitcnt lgkmcnt(10)
    v_mfma_f32_16x16x32_bf16 v[168:171], v[216:219], v[20:23], v[168:171]
    v_mfma_f32_16x16x32_bf16 v[184:187], v[216:219], v[36:39], v[184:187]
    ds_read_b64 v[208:209], v234 offset:12288
    ds_read_b64 v[210:211], v235 offset:12288
    s_waitcnt lgkmcnt(10)
    v_mfma_f32_16x16x32_bf16 v[168:171], v[220:223], v[24:27], v[168:171]
    v_mfma_f32_16x16x32_bf16 v[184:187], v[220:223], v[40:43], v[184:187]
    v_add_u32 v242, s61, v228
    ds_read_b64 v[212:213], v242
    v_add_u32 v243, s61, v229
    ds_read_b64 v[214:215], v243
    s_waitcnt lgkmcnt(10)
    v_mfma_f32_16x16x32_bf16 v[168:171], v[224:227], v[28:31], v[168:171]
    v_mfma_f32_16x16x32_bf16 v[184:187], v[224:227], v[44:47], v[184:187]
    v_add_u32 v242, s61, v230
    ds_read_b64 v[216:217], v242
    v_add_u32 v243, s61, v231
    ds_read_b64 v[218:219], v243
    s_waitcnt lgkmcnt(10)
    v_mfma_f32_16x16x32_bf16 v[172:175], v[196:199], v[16:19], 0
    v_mfma_f32_16x16x32_bf16 v[188:191], v[196:199], v[32:35], 0
    v_add_u32 v242, s61, v232
    ds_read_b64 v[220:221], v242
    v_add_u32 v243, s61, v233
    ds_read_b64 v[222:223], v243
    s_waitcnt lgkmcnt(10)
    v_mfma_f32_16x16x32_bf16 v[172:175], v[200:203], v[20:23], v[172:175]
    v_mfma_f32_16x16x32_bf16 v[188:191], v[200:203], v[36:39], v[188:191]
    v_add_u32 v242, s61, v234
    ds_read_b64 v[224:225], v242
    v_add_u32 v243, s61, v235
    ds_read_b64 v[226:227], v243
    s_waitcnt lgkmcnt(10)
    v_mfma_f32_16x16x32_bf16 v[172:175], v[204:207], v[24:27], v[172:175]
    v_mfma_f32_16x16x32_bf16 v[188:191], v[204:207], v[40:43], v[188:191]
    s_waitcnt lgkmcnt(8)
    v_mfma_f32_16x16x32_bf16 v[172:175], v[208:211], v[28:31], v[172:175]
    v_mfma_f32_16x16x32_bf16 v[188:191], v[208:211], v[44:47], v[188:191]
    s_waitcnt lgkmcnt(6)
    v_mfma_f32_16x16x32_bf16 v[192:195], v[212:215], v[48:51], 0
    s_waitcnt lgkmcnt(4)
    v_mfma_f32_16x16x32_bf16 v[192:195], v[216:219], v[52:55], v[192:195]
    s_waitcnt lgkmcnt(2)
    v_mfma_f32_16x16x32_bf16 v[192:195], v[220:223], v[56:59], v[192:195]
    s_waitcnt lgkmcnt(0)
    v_mfma_f32_16x16x32_bf16 v[192:195], v[224:227], v[60:63], v[192:195]
    s_barrier
    v_max3_f32 v250, v160, v161, v162
    v_max3_f32 v250, v250, v163, v164
    v_max3_f32 v250, v250, v165, v166
    v_max3_f32 v250, v250, v167, v168
    v_max3_f32 v250, v250, v169, v170
    v_max3_f32 v250, v250, v171, v172
    v_max3_f32 v250, v250, v173, v174
    v_max_f32 v250, v250, v175
    v_max3_f32 v251, v176, v177, v178
    v_max3_f32 v251, v251, v179, v180
    v_max3_f32 v251, v251, v181, v182
    v_max3_f32 v251, v251, v183, v184
    v_max3_f32 v251, v251, v185, v186
    v_max3_f32 v251, v251, v187, v188
    v_max3_f32 v251, v251, v189, v190
    v_max_f32 v251, v251, v191
    v_max3_f32 v252, v192, v193, v194
    v_max_f32 v252, v252, v195
    v_mov_b32 v253, v250
    s_nop 1
    v_permlane32_swap_b32 v250, v253
    v_max_f32 v250, v250, v253
    v_mov_b32 v253, v250
    s_nop 1
    v_permlane16_swap_b32 v250, v253
    v_max_f32 v250, v250, v253
    v_mov_b32 v254, v251
    s_nop 1
    v_permlane32_swap_b32 v251, v254
    v_max_f32 v251, v251, v254
    v_mov_b32 v254, v251
    s_nop 1
    v_permlane16_swap_b32 v251, v254
    v_max_f32 v251, v251, v254
    v_mov_b32 v253, v252
    s_nop 1
    v_permlane32_swap_b32 v252, v253
    v_max_f32 v252, v252, v253
    v_mov_b32 v253, v252
    s_nop 1
    v_permlane16_swap_b32 v252, v253
    v_max_f32 v252, v252, v253
    v_sub_f32 v244, v250, v236
    v_sub_f32 v245, v251, v237
    v_sub_f32 v246, v252, v238
    v_max3_f32 v253, v244, v245, v246
    v_cmp_lt_f32 vcc, s67, v253
    s_nop 4
    s_cbranch_vccz L_k1_nors4
    v_max_f32 v250, v250, v236
    v_sub_f32 v244, v236, v250
    v_mul_f32 v244, s62, v244
    v_exp_f32 v244, v244
    v_mov_b32 v236, v250
    v_max_f32 v251, v251, v237
    v_sub_f32 v245, v237, v251
    v_mul_f32 v245, s62, v245
    v_exp_f32 v245, v245
    v_mov_b32 v237, v251
    v_max_f32 v252, v252, v238
    v_sub_f32 v246, v238, v252
    v_mul_f32 v246, s62, v246
    v_exp_f32 v246, v246
    v_mov_b32 v238, v252
    v_mul_f32 v239, v239, v244
    v_mul_f32 v64, v64, v244
    v_mul_f32 v65, v65, v244
    v_mul_f32 v66, v66, v244
    v_mul_f32 v67, v67, v244
    v_mul_f32 v68, v68, v244
    v_mul_f32 v69, v69, v244
    v_mul_f32 v70, v70, v244
    v_mul_f32 v71, v71, v244
    v_mul_f32 v72, v72, v244
    v_mul_f32 v73, v73, v244
    v_mul_f32 v74, v74, v244
    v_mul_f32 v75, v75, v244
    v_mul_f32 v76, v76, v244
    v_mul_f32 v77, v77, v244
    v_mul_f32 v78, v78, v244
    v_mul_f32 v79, v79, v244
    v_mul_f32 v80, v80, v244
    v_mul_f32 v81, v81, v244
    v_mul_f32 v82, v82, v244
    v_mul_f32 v83, v83, v244
    v_mul_f32 v84, v84, v244
    v_mul_f32 v85, v85, v244
    v_mul_f32 v86, v86, v244
    v_mul_f32 v87, v87, v244
    v_mul_f32 v88, v88, v244
    v_mul_f32 v89, v89, v244
    v_mul_f32 v90, v90, v244
    v_mul_f32 v91, v91, v244
    v_mul_f32 v92, v92, v244
    v_mul_f32 v93, v93, v244
    v_mul_f32 v94, v94, v244
    v_mul_f32 v95, v95, v244
    v_mul_f32 v240, v240, v245
    v_mul_f32 v96, v96, v245
    v_mul_f32 v97, v97, v245
    v_mul_f32 v98, v98, v245
    v_mul_f32 v99, v99, v245
    v_mul_f32 v100, v100, v245
    v_mul_f32 v101, v101, v245
    v_mul_f32 v102, v102, v245
    v_mul_f32 v103, v103, v245
    v_mul_f32 v104, v104, v245
    v_mul_f32 v105, v105, v245
    v_mul_f32 v106, v106, v245
    v_mul_f32 v107, v107, v245
    v_mul_f32 v108, v108, v245
    v_mul_f32 v109, v109, v245
    v_mul_f32 v110, v110, v245
    v_mul_f32 v111, v111, v245
    v_mul_f32 v112, v112, v245
    v_mul_f32 v113, v113, v245
    v_mul_f32 v114, v114, v245
    v_mul_f32 v115, v115, v245
    v_mul_f32 v116, v116, v245
    v_mul_f32 v117, v117, v245
    v_mul_f32 v118, v118, v245
    v_mul_f32 v119, v119, v245
    v_mul_f32 v120, v120, v245
    v_mul_f32 v121, v121, v245
    v_mul_f32 v122, v122, v245
    v_mul_f32 v123, v123, v245
    v_mul_f32 v124, v124, v245
    v_mul_f32 v125, v125, v245
    v_mul_f32 v126, v126, v245
    v_mul_f32 v127, v127, v245
    v_mul_f32 v241, v241, v246
    v_mul_f32 v128, v128, v246
    v_mul_f32 v129, v129, v246
    v_mul_f32 v130, v130, v246
    v_mul_f32 v131, v131, v246
    v_mul_f32 v132, v132, v246
    v_mul_f32 v133, v133, v246
    v_mul_f32 v134, v134, v246
    v_mul_f32 v135, v135, v246
    v_mul_f32 v136, v136, v246
    v_mul_f32 v137, v137, v246
    v_mul_f32 v138, v138, v246
    v_mul_f32 v139, v139, v246
    v_mul_f32 v140, v140, v246
    v_mul_f32 v141, v141, v246
    v_mul_f32 v142, v142, v246
    v_mul_f32 v143, v143, v246
    v_mul_f32 v144, v144, v246
    v_mul_f32 v145, v145, v246
    v_mul_f32 v146, v146, v246
    v_mul_f32 v147, v147, v246
    v_mul_f32 v148, v148, v246
    v_mul_f32 v149, v149, v246
    v_mul_f32 v150, v150, v246
    v_mul_f32 v151, v151, v246
    v_mul_f32 v152, v152, v246
    v_mul_f32 v153, v153, v246
    v_mul_f32 v154, v154, v246
    v_mul_f32 v155, v155, v246
    v_mul_f32 v156, v156, v246
    v_mul_f32 v157, v157, v246
    v_mul_f32 v158, v158, v246
    v_mul_f32 v159, v159, v246
L_k1_nors4:
    s_nop 1
    v_mul_f32 v247, s62, v236
    v_mul_f32 v248, s62, v237
    v_mul_f32 v249, s62, v238
    v_fma_f32 v160, v160, s62, -v247
    v_fma_f32 v161, v161, s62, -v247
    v_fma_f32 v162, v162, s62, -v247
    v_fma_f32 v163, v163, s62, -v247
    v_fma_f32 v164, v164, s62, -v247
    v_fma_f32 v165, v165, s62, -v247
    v_fma_f32 v166, v166, s62, -v247
    v_fma_f32 v167, v167, s62, -v247
    v_fma_f32 v168, v168, s62, -v247
    v_fma_f32 v169, v169, s62, -v247
    v_fma_f32 v170, v170, s62, -v247
    v_fma_f32 v171, v171, s62, -v247
    v_fma_f32 v172, v172, s62, -v247
    v_fma_f32 v173, v173, s62, -v247
    v_fma_f32 v174, v174, s62, -v247
    v_fma_f32 v175, v175, s62, -v247
    v_exp_f32 v160, v160
    v_exp_f32 v161, v161
    v_exp_f32 v162, v162
    v_exp_f32 v163, v163
    v_exp_f32 v164, v164
    v_exp_f32 v165, v165
    v_exp_f32 v166, v166
    v_exp_f32 v167, v167
    v_exp_f32 v168, v168
    v_exp_f32 v169, v169
    v_exp_f32 v170, v170
    v_exp_f32 v171, v171
    v_exp_f32 v172, v172
    v_exp_f32 v173, v173
    v_exp_f32 v174, v174
    v_exp_f32 v175, v175
    v_add_f32 v239, v239, v160
    v_add_f32 v239, v239, v161
    v_add_f32 v239, v239, v162
    v_add_f32 v239, v239, v163
    v_add_f32 v239, v239, v164
    v_add_f32 v239, v239, v165
    v_add_f32 v239, v239, v166
    v_add_f32 v239, v239, v167
    v_add_f32 v239, v239, v168
    v_add_f32 v239, v239, v169
    v_add_f32 v239, v239, v170
    v_add_f32 v239, v239, v171
    v_add_f32 v239, v239, v172
    v_add_f32 v239, v239, v173
    v_add_f32 v239, v239, v174
    v_add_f32 v239, v239, v175
    v_cvt_pk_bf16_f32 v160, v160, v161
    v_cvt_pk_bf16_f32 v161, v162, v163
    v_cvt_pk_bf16_f32 v162, v164, v165
    v_cvt_pk_bf16_f32 v163, v166, v167
    v_cvt_pk_bf16_f32 v168, v168, v169
    v_cvt_pk_bf16_f32 v169, v170, v171
    v_cvt_pk_bf16_f32 v170, v172, v173
    v_cvt_pk_bf16_f32 v171, v174, v175
    v_fma_f32 v176, v176, s62, -v248
    v_fma_f32 v177, v177, s62, -v248
    v_fma_f32 v178, v178, s62, -v248
    v_fma_f32 v179, v179, s62, -v248
    v_fma_f32 v180, v180, s62, -v248
    v_fma_f32 v181, v181, s62, -v248
    v_fma_f32 v182, v182, s62, -v248
    v_fma_f32 v183, v183, s62, -v248
    v_fma_f32 v184, v184, s62, -v248
    v_fma_f32 v185, v185, s62, -v248
    v_fma_f32 v186, v186, s62, -v248
    v_fma_f32 v187, v187, s62, -v248
    v_fma_f32 v188, v188, s62, -v248
    v_fma_f32 v189, v189, s62, -v248
    v_fma_f32 v190, v190, s62, -v248
    v_fma_f32 v191, v191, s62, -v248
    v_exp_f32 v176, v176
    v_exp_f32 v177, v177
    v_exp_f32 v178, v178
    v_exp_f32 v179, v179
    v_exp_f32 v180, v180
    v_exp_f32 v181, v181
    v_exp_f32 v182, v182
    v_exp_f32 v183, v183
    v_exp_f32 v184, v184
    v_exp_f32 v185, v185
    v_exp_f32 v186, v186
    v_exp_f32 v187, v187
    v_exp_f32 v188, v188
    v_exp_f32 v189, v189
    v_exp_f32 v190, v190
    v_exp_f32 v191, v191
    v_add_f32 v240, v240, v176
    v_add_f32 v240, v240, v177
    v_add_f32 v240, v240, v178
    v_add_f32 v240, v240, v179
    v_add_f32 v240, v240, v180
    v_add_f32 v240, v240, v181
    v_add_f32 v240, v240, v182
    v_add_f32 v240, v240, v183
    v_add_f32 v240, v240, v184
    v_add_f32 v240, v240, v185
    v_add_f32 v240, v240, v186
    v_add_f32 v240, v240, v187
    v_add_f32 v240, v240, v188
    v_add_f32 v240, v240, v189
    v_add_f32 v240, v240, v190
    v_add_f32 v240, v240, v191
    v_cvt_pk_bf16_f32 v176, v176, v177
    v_cvt_pk_bf16_f32 v177, v178, v179
    v_cvt_pk_bf16_f32 v178, v180, v181
    v_cvt_pk_bf16_f32 v179, v182, v183
    v_cvt_pk_bf16_f32 v184, v184, v185
    v_cvt_pk_bf16_f32 v185, v186, v187
    v_cvt_pk_bf16_f32 v186, v188, v189
    v_cvt_pk_bf16_f32 v187, v190, v191
    v_fma_f32 v192, v192, s62, -v249
    v_fma_f32 v193, v193, s62, -v249
    v_fma_f32 v194, v194, s62, -v249
    v_fma_f32 v195, v195, s62, -v249
    v_exp_f32 v192, v192
    v_exp_f32 v193, v193
    v_exp_f32 v194, v194
    v_exp_f32 v195, v195
    v_add_f32 v241, v241, v192
    v_add_f32 v241, v241, v193
    v_add_f32 v241, v241, v194
    v_add_f32 v241, v241, v195
    v_cvt_pk_bf16_f32 v192, v192, v193
    v_cvt_pk_bf16_f32 v193, v194, v195
    s_sub_u32 s63, s63, 1
    s_cmp_lg_u32 s63, 0
    s_nop 5
    s_cbranch_scc1 L_k1_attn
    s_waitcnt vmcnt(8)
    s_barrier
    s_mov_b32 s16, s34
    s_and_b32 s17, s35, 0xffff
    s_mov_b32 s18, 5242880
    s_mov_b32 s19, 0x20000
    s_mul_i32 s7, s38, 163840
    s_and_b32 s68, s2, 1
    s_mul_i32 s68, s68, 640
    s_add_u32 s7, s7, s68
    s_mov_b32 s68, 52429
    s_lshl_b32 s20, s73, 6
    v_add_u32 v13, s20, v1
    v_mul_lo_u32 v14, v13, s68
    v_lshrrev_b32 v14, 18, v14
    v_mul_u32_u24 v15, 5, v14
    v_sub_u32 v15, v13, v15
    v_mul_u32_u24 v14, 1280, v14
    v_lshlrev_b32 v15, 7, v15
    v_add_u32 v14, v14, v15
    v_mov_b32 v15, 0x7ffffff0
    v_cmp_gt_u32 vcc, 640, v13
    s_nop 1
    v_cndmask_b32 v14, v15, v14, vcc
    buffer_load_dword v255, v14, s[16:19], s7 offen
    s_lshl_b32 s20, s73, 6
    s_add_u32 s20, s20, 512
    v_add_u32 v13, s20, v1
    v_mul_lo_u32 v14, v13, s68
    v_lshrrev_b32 v14, 18, v14
    v_mul_u32_u24 v15, 5, v14
    v_sub_u32 v15, v13, v15
    v_mul_u32_u24 v14, 1280, v14
    v_lshlrev_b32 v15, 7, v15
    v_add_u32 v14, v14, v15
    v_mov_b32 v15, 0x7ffffff0
    v_cmp_gt_u32 vcc, 640, v13
    s_nop 1
    v_cndmask_b32 v14, v15, v14, vcc
    buffer_load_dword v255, v14, s[16:19], s7 offen
    v_add_u32 v228, s77, v9
    v_xor_b32 v229, 32, v228
    v_xor_b32 v230, 64, v228
    v_xor_b32 v231, 96, v228
    v_xor_b32 v232, 128, v228
    v_xor_b32 v233, 160, v228
    v_xor_b32 v234, 192, v228
    v_xor_b32 v235, 224, v228
    s_add_u32 s77, s77, 16384
    s_cmp_eq_u32 s77, s97
    s_cselect_b32 s77, s72, s77
    ds_read_b64_tr_b16 v[196:197], v228 offset:0
    ds_read_b64_tr_b16 v[198:199], v228 offset:4096
    ds_read_b64_tr_b16 v[200:201], v229 offset:0
    ds_read_b64_tr_b16 v[202:203], v229 offset:4096
    ds_read_b64_tr_b16 v[204:205], v230 offset:0
    ds_read_b64_tr_b16 v[206:207], v230 offset:4096
    ds_read_b64_tr_b16 v[208:209], v231 offset:0
    ds_read_b64_tr_b16 v[210:211], v231 offset:4096
    ds_read_b64_tr_b16 v[212:213], v232 offset:0
    ds_read_b64_tr_b16 v[214:215], v232 offset:4096
    ds_read_b64_tr_b16 v[216:217], v233 offset:0
    ds_read_b64_tr_b16 v[218:219], v233 offset:4096
    s_waitcnt lgkmcnt(10)
    v_mfma_f32_16x16x32_bf16 v[64:67], v[196:199], v[160:163], v[64:67]
    v_mfma_f32_16x16x32_bf16 v[96:99], v[196:199], v[176:179], v[96:99]
    ds_read_b64_tr_b16 v[220:221], v234 offset:0
    ds_read_b64_tr_b16 v[222:223], v234 offset:4096
    s_waitcnt lgkmcnt(10)
    v_mfma_f32_16x16x32_bf16 v[68:71], v[200:203], v[160:163], v[68:71]
    v_mfma_f32_16x16x32_bf16 v[100:103], v[200:203], v[176:179], v[100:103]
    ds_read_b64_tr_b16 v[224:225], v235 offset:0
    ds_read_b64_tr_b16 v[226:227], v235 offset:4096
    s_waitcnt lgkmcnt(10)
    v_mfma_f32_16x16x32_bf16 v[72:75], v[204:207], v[160:163], v[72:75]
    v_mfma_f32_16x16x32_bf16 v[104:107], v[204:207], v[176:179], v[104:107]
    ds_read_b64_tr_b16 v[196:197], v228 offset:8192
    ds_read_b64_tr_b16 v[198:199], v228 offset:12288
    s_waitcnt lgkmcnt(10)
    v_mfma_f32_16x16x32_bf16 v[76:79], v[208:211], v[160:163], v[76:79]
    v_mfma_f32_16x16x32_bf16 v[108:111], v[208:211], v[176:179], v[108:111]
    ds_read_b64_tr_b16 v[200:201], v229 offset:8192
    ds_read_b64_tr_b16 v[202:203], v229 offset:12288
    s_waitcnt lgkmcnt(10)
    v_mfma_f32_16x16x32_bf16 v[80:83], v[212:215], v[160:163], v[80:83]
    v_mfma_f32_16x16x32_bf16 v[112:115], v[212:215], v[176:179], v[112:115]
    ds_read_b64_tr_b16 v[204:205], v230 offset:8192
    ds_read_b64_tr_b16 v[206:207], v230 offset:12288
    s_waitcnt lgkmcnt(10)
    v_mfma_f32_16x16x32_bf16 v[84:87], v[216:219], v[160:163], v[84:87]
    v_mfma_f32_16x16x32_bf16 v[116:119], v[216:219], v[176:179], v[116:119]
    ds_read_b64_tr_b16 v[208:209], v231 offset:8192
    ds_read_b64_tr_b16 v[210:211], v231 offset:12288
    s_waitcnt lgkmcnt(10)
    v_mfma_f32_16x16x32_bf16 v[88:91], v[220:223], v[160:163], v[88:91]
    v_mfma_f32_16x16x32_bf16 v[120:123], v[220:223], v[176:179], v[120:123]
    ds_read_b64_tr_b16 v[212:213], v232 offset:8192
    ds_read_b64_tr_b16 v[214:215], v232 offset:12288
    s_waitcnt lgkmcnt(10)
    v_mfma_f32_16x16x32_bf16 v[92:95], v[224:227], v[160:163], v[92:95]
    v_mfma_f32_16x16x32_bf16 v[124:127], v[224:227], v[176:179], v[124:127]
    ds_read_b64_tr_b16 v[216:217], v233 offset:8192
    ds_read_b64_tr_b16 v[218:219], v233 offset:12288
    s_waitcnt lgkmcnt(10)
    v_mfma_f32_16x16x32_bf16 v[64:67], v[196:199], v[168:171], v[64:67]
    v_mfma_f32_16x16x32_bf16 v[96:99], v[196:199], v[184:187], v[96:99]
    ds_read_b64_tr_b16 v[220:221], v234 offset:8192
    ds_read_b64_tr_b16 v[222:223], v234 offset:12288
    s_waitcnt lgkmcnt(10)
    v_mfma_f32_16x16x32_bf16 v[68:71], v[200:203], v[168:171], v[68:71]
    v_mfma_f32_16x16x32_bf16 v[100:103], v[200:203], v[184:187], v[100:103]
    ds_read_b64_tr_b16 v[224:225], v235 offset:8192
    ds_read_b64_tr_b16 v[226:227], v235 offset:12288
    s_waitcnt lgkmcnt(10)
    v_mfma_f32_16x16x32_bf16 v[72:75], v[204:207], v[168:171], v[72:75]
    v_mfma_f32_16x16x32_bf16 v[104:107], v[204:207], v[184:187], v[104:107]
    v_add_u32 v242, s61, v228
    ds_read_b64_tr_b16 v[196:197], v242
    v_add_u32 v243, s61, v229
    ds_read_b64_tr_b16 v[198:199], v243
    s_waitcnt lgkmcnt(10)
    v_mfma_f32_16x16x32_bf16 v[76:79], v[208:211], v[168:171], v[76:79]
    v_mfma_f32_16x16x32_bf16 v[108:111], v[208:211], v[184:187], v[108:111]
    v_add_u32 v242, s61, v230
    ds_read_b64_tr_b16 v[200:201], v242
    v_add_u32 v243, s61, v231
    ds_read_b64_tr_b16 v[202:203], v243
    s_waitcnt lgkmcnt(10)
    v_mfma_f32_16x16x32_bf16 v[80:83], v[212:215], v[168:171], v[80:83]
    v_mfma_f32_16x16x32_bf16 v[112:115], v[212:215], v[184:187], v[112:115]
    v_add_u32 v242, s61, v232
    ds_read_b64_tr_b16 v[204:205], v242
    v_add_u32 v243, s61, v233
    ds_read_b64_tr_b16 v[206:207], v243
    s_waitcnt lgkmcnt(10)
    v_mfma_f32_16x16x32_bf16 v[84:87], v[216:219], v[168:171], v[84:87]
    v_mfma_f32_16x16x32_bf16 v[116:119], v[216:219], v[184:187], v[116:119]
    v_add_u32 v242, s61, v234
    ds_read_b64_tr_b16 v[208:209], v242
    v_add_u32 v243, s61, v235
    ds_read_b64_tr_b16 v[210:211], v243
    s_waitcnt lgkmcnt(10)
    v_mfma_f32_16x16x32_bf16 v[88:91], v[220:223], v[168:171], v[88:91]
    v_mfma_f32_16x16x32_bf16 v[120:123], v[220:223], v[184:187], v[120:123]
    s_waitcnt lgkmcnt(8)
    v_mfma_f32_16x16x32_bf16 v[92:95], v[224:227], v[168:171], v[92:95]
    v_mfma_f32_16x16x32_bf16 v[124:127], v[224:227], v[184:187], v[124:127]
    s_waitcnt lgkmcnt(7)
    v_mfma_f32_16x16x16_bf16 v[128:131], v[196:197], v[192:193], v[128:131]
    s_waitcnt lgkmcnt(6)
    v_mfma_f32_16x16x16_bf16 v[132:135], v[198:199], v[192:193], v[132:135]
    s_waitcnt lgkmcnt(5)
    v_mfma_f32_16x16x16_bf16 v[136:139], v[200:201], v[192:193], v[136:139]
    s_waitcnt lgkmcnt(4)
    v_mfma_f32_16x16x16_bf16 v[140:143], v[202:203], v[192:193], v[140:143]
    s_waitcnt lgkmcnt(3)
    v_mfma_f32_16x16x16_bf16 v[144:147], v[204:205], v[192:193], v[144:147]
    s_waitcnt lgkmcnt(2)
    v_mfma_f32_16x16x16_bf16 v[148:151], v[206:207], v[192:193], v[148:151]
    s_waitcnt lgkmcnt(1)
    v_mfma_f32_16x16x16_bf16 v[152:155], v[208:209], v[192:193], v[152:155]
    s_waitcnt lgkmcnt(0)
    v_mfma_f32_16x16x16_bf16 v[156:159], v[210:211], v[192:193], v[156:159]
    s_cmp_ge_u32 s73, 4
    s_cbranch_scc1 L_k1_st1
    s_barrier
L_k1_st1:
    s_waitcnt vmcnt(6)
    s_waitcnt vmcnt(2)
    s_barrier
    v_mov_b32 v253, v239
    s_nop 1
    v_permlane32_swap_b32 v239, v253
    v_add_f32 v239, v239, v253
    v_mov_b32 v253, v239
    s_nop 1
    v_permlane16_swap_b32 v239, v253
    v_add_f32 v239, v239, v253
    v_mov_b32 v254, v240
    s_nop 1
    v_permlane32_swap_b32 v240, v254
    v_add_f32 v240, v240, v254
    v_mov_b32 v254, v240
    s_nop 1
    v_permlane16_swap_b32 v240, v254
    v_add_f32 v240, v240, v254
    v_mov_b32 v253, v241
    s_nop 1
    v_permlane32_swap_b32 v241, v253
    v_add_f32 v241, v241, v253
    v_mov_b32 v253, v241
    s_nop 1
    v_permlane16_swap_b32 v241, v253
    v_add_f32 v241, v241, v253
    s_lshl_b32 s7, s60, 13
    s_add_u32 s7, s7, s72
    v_add_u32 v13, s7, v12
    ds_write_b128 v13, v[128:131] offset:0
    ds_write_b128 v13, v[132:135] offset:1024
    ds_write_b128 v13, v[136:139] offset:2048
    ds_write_b128 v13, v[140:143] offset:3072
    ds_write_b128 v13, v[144:147] offset:4096
    ds_write_b128 v13, v[148:151] offset:5120
    ds_write_b128 v13, v[152:155] offset:6144
    ds_write_b128 v13, v[156:159] offset:7168
    v_mov_b32 v242, v238
    v_mov_b32 v243, v241
    s_lshl_b32 s7, s60, 9
    v_lshlrev_b32 v14, 3, v1
    s_add_u32 s68, s72, 32768
    v_add_u32 v14, s68, v14
    v_add_u32 v15, s7, v14
    ds_write_b64 v15, v[242:243]
    v_rcp_f32 v244, v239
    s_nop 0
    v_mul_f32 v64, v64, v244
    v_mul_f32 v65, v65, v244
    v_mul_f32 v66, v66, v244
    v_mul_f32 v67, v67, v244
    v_mul_f32 v68, v68, v244
    v_mul_f32 v69, v69, v244
    v_mul_f32 v70, v70, v244
    v_mul_f32 v71, v71, v244
    v_mul_f32 v72, v72, v244
    v_mul_f32 v73, v73, v244
    v_mul_f32 v74, v74, v244
    v_mul_f32 v75, v75, v244
    v_mul_f32 v76, v76, v244
    v_mul_f32 v77, v77, v244
    v_mul_f32 v78, v78, v244
    v_mul_f32 v79, v79, v244
    v_mul_f32 v80, v80, v244
    v_mul_f32 v81, v81, v244
    v_mul_f32 v82, v82, v244
    v_mul_f32 v83, v83, v244
    v_mul_f32 v84, v84, v244
    v_mul_f32 v85, v85, v244
    v_mul_f32 v86, v86, v244
    v_mul_f32 v87, v87, v244
    v_mul_f32 v88, v88, v244
    v_mul_f32 v89, v89, v244
    v_mul_f32 v90, v90, v244
    v_mul_f32 v91, v91, v244
    v_mul_f32 v92, v92, v244
    v_mul_f32 v93, v93, v244
    v_mul_f32 v94, v94, v244
    v_mul_f32 v95, v95, v244
    v_cvt_pk_bf16_f32 v64, v64, v65
    v_cvt_pk_bf16_f32 v65, v66, v67
    v_cvt_pk_bf16_f32 v66, v68, v69
    v_cvt_pk_bf16_f32 v67, v70, v71
    buffer_store_dwordx4 v[64:67], v12, s[56:59], s69 offen offset:0
    v_cvt_pk_bf16_f32 v72, v72, v73
    v_cvt_pk_bf16_f32 v73, v74, v75
    v_cvt_pk_bf16_f32 v74, v76, v77
    v_cvt_pk_bf16_f32 v75, v78, v79
    buffer_store_dwordx4 v[72:75], v12, s[56:59], s69 offen offset:1024
    v_cvt_pk_bf16_f32 v80, v80, v81
    v_cvt_pk_bf16_f32 v81, v82, v83
    v_cvt_pk_bf16_f32 v82, v84, v85
    v_cvt_pk_bf16_f32 v83, v86, v87
    buffer_store_dwordx4 v[80:83], v12, s[56:59], s69 offen offset:2048
    v_cvt_pk_bf16_f32 v88, v88, v89
    v_cvt_pk_bf16_f32 v89, v90, v91
    v_cvt_pk_bf16_f32 v90, v92, v93
    v_cvt_pk_bf16_f32 v91, v94, v95
    buffer_store_dwordx4 v[88:91], v12, s[56:59], s69 offen offset:3072
    v_rcp_f32 v245, v240
    s_nop 0
    v_mul_f32 v96, v96, v245
    v_mul_f32 v97, v97, v245
    v_mul_f32 v98, v98, v245
    v_mul_f32 v99, v99, v245
    v_mul_f32 v100, v100, v245
    v_mul_f32 v101, v101, v245
    v_mul_f32 v102, v102, v245
    v_mul_f32 v103, v103, v245
    v_mul_f32 v104, v104, v245
    v_mul_f32 v105, v105, v245
    v_mul_f32 v106, v106, v245
    v_mul_f32 v107, v107, v245
    v_mul_f32 v108, v108, v245
    v_mul_f32 v109, v109, v245
    v_mul_f32 v110, v110, v245
    v_mul_f32 v111, v111, v245
    v_mul_f32 v112, v112, v245
    v_mul_f32 v113, v113, v245
    v_mul_f32 v114, v114, v245
    v_mul_f32 v115, v115, v245
    v_mul_f32 v116, v116, v245
    v_mul_f32 v117, v117, v245
    v_mul_f32 v118, v118, v245
    v_mul_f32 v119, v119, v245
    v_mul_f32 v120, v120, v245
    v_mul_f32 v121, v121, v245
    v_mul_f32 v122, v122, v245
    v_mul_f32 v123, v123, v245
    v_mul_f32 v124, v124, v245
    v_mul_f32 v125, v125, v245
    v_mul_f32 v126, v126, v245
    v_mul_f32 v127, v127, v245
    v_cvt_pk_bf16_f32 v96, v96, v97
    v_cvt_pk_bf16_f32 v97, v98, v99
    v_cvt_pk_bf16_f32 v98, v100, v101
    v_cvt_pk_bf16_f32 v99, v102, v103
    buffer_store_dwordx4 v[96:99], v12, s[56:59], s70 offen offset:0
    v_cvt_pk_bf16_f32 v104, v104, v105
    v_cvt_pk_bf16_f32 v105, v106, v107
    v_cvt_pk_bf16_f32 v106, v108, v109
    v_cvt_pk_bf16_f32 v107, v110, v111
    buffer_store_dwordx4 v[104:107], v12, s[56:59], s70 offen offset:1024
    v_cvt_pk_bf16_f32 v112, v112, v113
    v_cvt_pk_bf16_f32 v113, v114, v115
    v_cvt_pk_bf16_f32 v114, v116, v117
    v_cvt_pk_bf16_f32 v115, v118, v119
    buffer_store_dwordx4 v[112:115], v12, s[56:59], s70 offen offset:2048
    v_cvt_pk_bf16_f32 v120, v120, v121
    v_cvt_pk_bf16_f32 v121, v122, v123
    v_cvt_pk_bf16_f32 v122, v124, v125
    v_cvt_pk_bf16_f32 v123, v126, v127
    buffer_store_dwordx4 v[120:123], v12, s[56:59], s70 offen offset:3072
    s_waitcnt lgkmcnt(0)
    s_barrier
    ds_read_b64 v[160:161], v14 offset:0
    ds_read_b64 v[162:163], v14 offset:512
    ds_read_b64 v[164:165], v14 offset:1024
    ds_read_b64 v[166:167], v14 offset:1536
    s_add_u32 s7, s76, s72
    v_add_u32 v13, s7, v12
    ds_read_b128 v[196:199], v13 offset:0
    ds_read_b128 v[200:203], v13 offset:1024
    ds_read_b128 v[204:207], v13 offset:8192
    ds_read_b128 v[208:211], v13 offset:9216
    ds_read_b128 v[212:215], v13 offset:16384
    ds_read_b128 v[216:219], v13 offset:17408
    ds_read_b128 v[220:223], v13 offset:24576
    ds_read_b128 v[224:227], v13 offset:25600
    s_waitcnt lgkmcnt(9)
    v_max3_f32 v242, v160, v162, v164
    s_waitcnt lgkmcnt(8)
    v_max_f32 v242, v242, v166
    v_mul_f32 v242, s62, v242
    v_fma_f32 v243, v160, s62, -v242
    v_fma_f32 v244, v162, s62, -v242
    v_fma_f32 v245, v164, s62, -v242
    v_fma_f32 v246, v166, s62, -v242
    v_exp_f32 v243, v243
    v_exp_f32 v244, v244
    v_exp_f32 v245, v245
    v_exp_f32 v246, v246
    v_mul_f32 v247, v161, v243
    v_fma_f32 v247, v163, v244, v247
    v_fma_f32 v247, v165, v245, v247
    v_fma_f32 v247, v167, v246, v247
    v_rcp_f32 v247, v247
    s_nop 0
    v_mul_f32 v243, v243, v247
    v_mul_f32 v244, v244, v247
    v_mul_f32 v245, v245, v247
    v_mul_f32 v246, v246, v247
    s_waitcnt lgkmcnt(7)
    v_mul_f32 v196, v196, v243
    s_waitcnt lgkmcnt(5)
    v_fma_f32 v196, v204, v244, v196
    s_waitcnt lgkmcnt(3)
    v_fma_f32 v196, v212, v245, v196
    s_waitcnt lgkmcnt(1)
    v_fma_f32 v196, v220, v246, v196
    v_mul_f32 v197, v197, v243
    v_fma_f32 v197, v205, v244, v197
    v_fma_f32 v197, v213, v245, v197
    v_fma_f32 v197, v221, v246, v197
    v_mul_f32 v198, v198, v243
    v_fma_f32 v198, v206, v244, v198
    v_fma_f32 v198, v214, v245, v198
    v_fma_f32 v198, v222, v246, v198
    v_mul_f32 v199, v199, v243
    v_fma_f32 v199, v207, v244, v199
    v_fma_f32 v199, v215, v245, v199
    v_fma_f32 v199, v223, v246, v199
    v_mul_f32 v200, v200, v243
    v_fma_f32 v200, v208, v244, v200
    v_fma_f32 v200, v216, v245, v200
    s_waitcnt lgkmcnt(0)
    v_fma_f32 v200, v224, v246, v200
    v_mul_f32 v201, v201, v243
    v_fma_f32 v201, v209, v244, v201
    v_fma_f32 v201, v217, v245, v201
    v_fma_f32 v201, v225, v246, v201
    v_mul_f32 v202, v202, v243
    v_fma_f32 v202, v210, v244, v202
    v_fma_f32 v202, v218, v245, v202
    v_fma_f32 v202, v226, v246, v202
    v_mul_f32 v203, v203, v243
    v_fma_f32 v203, v211, v244, v203
    v_fma_f32 v203, v219, v245, v203
    v_fma_f32 v203, v227, v246, v203
    v_cvt_pk_bf16_f32 v196, v196, v197
    v_cvt_pk_bf16_f32 v197, v198, v199
    v_cvt_pk_bf16_f32 v198, v200, v201
    v_cvt_pk_bf16_f32 v199, v202, v203
    buffer_store_dwordx4 v[196:199], v12, s[56:59], s71 offen
L_k1_end:
    s_endpgm
.globl k2_oproj_kernel
.p2align 8
.type k2_oproj_kernel,@function
k2_oproj_kernel:
    s_cmp_ge_u32 s2, 240
    s_cbranch_scc1 L_k2_end
    s_load_dwordx2 s[16:17], s[0:1], 32
    s_load_dwordx2 s[18:19], s[0:1], 72
    s_load_dwordx2 s[20:21], s[0:1], 80
    s_load_dwordx2 s[22:23], s[0:1], 96
    s_and_b32 s3, s2, 7
    s_lshr_b32 s4, s2, 3
    s_mul_i32 s5, s4, 43
    s_lshr_b32 s5, s5, 8
    s_mul_i32 s6, s5, 6
    s_sub_u32 s6, s4, s6
    s_lshr_b32 s7, s3, 2
    s_bfe_u32 s8, s3, 0x10001
    s_mul_i32 s8, s8, 6
    s_add_u32 s8, s8, s6
    s_and_b32 s9, s3, 1
    s_mul_i32 s9, s9, 5
    s_add_u32 s9, s9, s5
    v_and_b32 v1, 63, v0
    v_lshrrev_b32 v13, 6, v0
    v_and_b32 v2, 15, v0
    v_lshrrev_b32 v3, 4, v1
    v_readfirstlane_b32 s60, v13
    s_waitcnt lgkmcnt(0)
    s_cmp_eq_u32 s7, 0
    s_cselect_b64 s[10:11], s[16:17], s[18:19]
    s_lshl_b32 s12, s9, 7
    s_add_u32 s44, s10, s12
    s_addc_u32 s45, s11, 0
    s_and_b32 s45, s45, 0xffff
    s_sub_u32 s46, 5242880, s12
    s_mov_b32 s47, 0x20000
    s_mul_i32 s12, s7, 9437184
    s_add_u32 s40, s22, s12
    s_addc_u32 s41, s23, 0
    s_and_b32 s41, s41, 0xffff
    s_mov_b32 s42, 9437184
    s_mov_b32 s43, 0x20000
    s_mov_b32 s48, s20
    s_and_b32 s49, s21, 0xffff
    s_mov_b32 s50, 2949120
    s_mov_b32 s51, 0x20000
    s_and_b32 s24, s60, 3
    s_lshr_b32 s25, s60, 2
    s_lshl_b32 s13, s24, 10
    s_mul_i32 s12, s25, 36864
    s_add_u32 s13, s13, s12
    s_mul_i32 s71, s24, 40960
    s_mul_i32 s12, s25, 163840
    s_add_u32 s71, s71, s12
    v_lshlrev_b32 v248, 4, v1
    s_mul_i32 s12, s8, 6
    s_add_u32 s12, s12, 0
    s_mul_i32 s14, s12, 57
    s_lshr_b32 s14, s14, 9
    s_mul_i32 s15, s14, 9
    s_sub_u32 s15, s12, s15
    s_mul_i32 s14, s14, 1179648
    s_lshl_b32 s15, s15, 12
    s_add_u32 s14, s14, s15
    s_add_u32 s64, s14, s13
    s_mul_i32 s12, s8, 6
    s_add_u32 s12, s12, 1
    s_mul_i32 s14, s12, 57
    s_lshr_b32 s14, s14, 9
    s_mul_i32 s15, s14, 9
    s_sub_u32 s15, s12, s15
    s_mul_i32 s14, s14, 1179648
    s_lshl_b32 s15, s15, 12
    s_add_u32 s14, s14, s15
    s_add_u32 s65, s14, s13
    s_mul_i32 s12, s8, 6
    s_add_u32 s12, s12, 2
    s_mul_i32 s14, s12, 57
    s_lshr_b32 s14, s14, 9
    s_mul_i32 s15, s14, 9
    s_sub_u32 s15, s12, s15
    s_mul_i32 s14, s14, 1179648
    s_lshl_b32 s15, s15, 12
    s_add_u32 s14, s14, s15
    s_add_u32 s66, s14, s13
    s_mul_i32 s12, s8, 6
    s_add_u32 s12, s12, 3
    s_mul_i32 s14, s12, 57
    s_lshr_b32 s14, s14, 9
    s_mul_i32 s15, s14, 9
    s_sub_u32 s15, s12, s15
    s_mul_i32 s14, s14, 1179648
    s_lshl_b32 s15, s15, 12
    s_add_u32 s14, s14, s15
    s_add_u32 s67, s14, s13
    s_mul_i32 s12, s8, 6
    s_add_u32 s12, s12, 4
    s_mul_i32 s14, s12, 57
    s_lshr_b32 s14, s14, 9
    s_mul_i32 s15, s14, 9
    s_sub_u32 s15, s12, s15
    s_mul_i32 s14, s14, 1179648
    s_lshl_b32 s15, s15, 12
    s_add_u32 s14, s14, s15
    s_add_u32 s68, s14, s13
    s_mul_i32 s12, s8, 6
    s_add_u32 s12, s12, 5
    s_mul_i32 s14, s12, 57
    s_lshr_b32 s14, s14, 9
    s_mul_i32 s15, s14, 9
    s_sub_u32 s15, s12, s15
    s_mul_i32 s14, s14, 1179648
    s_lshl_b32 s15, s15, 12
    s_add_u32 s14, s14, s15
    s_add_u32 s69, s14, s13
    s_lshl_b32 s70, s60, 14
    v_lshrrev_b32 v13, 3, v1
    v_and_b32 v14, 6, v13
    v_and_b32 v15, 7, v1
    v_xor_b32 v14, v14, v15
    v_lshlrev_b32 v14, 4, v14
    v_mul_u32_u24 v13, 1280, v13
    v_add_u32 v244, v13, v14
    v_add_u32 v245, 9216, v244
    v_add_u32 v246, 18432, v244
    v_add_u32 v247, 27648, v244
    v_lshrrev_b32 v13, 2, v1
    v_lshrrev_b32 v14, 1, v13
    v_and_b32 v14, 3, v14
    v_lshlrev_b32 v14, 5, v14
    v_lshlrev_b32 v13, 7, v13
    v_add_u32 v13, v13, v14
    v_and_b32 v14, 3, v1
    v_lshlrev_b32 v14, 3, v14
    v_add_u32 v13, v13, v14
    v_add_u32 v240, s70, v13
    v_xor_b32 v241, 32, v240
    v_xor_b32 v242, 64, v240
    v_xor_b32 v243, 96, v240
    v_mov_b32 v16, 0
    v_mov_b32 v17, 0
    v_mov_b32 v18, 0
    v_mov_b32 v19, 0
    v_mov_b32 v20, 0
    v_mov_b32 v21, 0
    v_mov_b32 v22, 0
    v_mov_b32 v23, 0
    v_mov_b32 v24, 0
    v_mov_b32 v25, 0
    v_mov_b32 v26, 0
    v_mov_b32 v27, 0
    v_mov_b32 v28, 0
    v_mov_b32 v29, 0
    v_mov_b32 v30, 0
    v_mov_b32 v31, 0
    v_mov_b32 v32, 0
    v_mov_b32 v33, 0
    v_mov_b32 v34, 0
    v_mov_b32 v35, 0
    v_mov_b32 v36, 0
    v_mov_b32 v37, 0
    v_mov_b32 v38, 0
    v_mov_b32 v39, 0
    v_mov_b32 v40, 0
    v_mov_b32 v41, 0
    v_mov_b32 v42, 0
    v_mov_b32 v43, 0
    v_mov_b32 v44, 0
    v_mov_b32 v45, 0
    v_mov_b32 v46, 0
    v_mov_b32 v47, 0
    v_mov_b32 v48, 0
    v_mov_b32 v49, 0
    v_mov_b32 v50, 0
    v_mov_b32 v51, 0
    v_mov_b32 v52, 0
    v_mov_b32 v53, 0
    v_mov_b32 v54, 0
    v_mov_b32 v55, 0
    v_mov_b32 v56, 0
    v_mov_b32 v57, 0
    v_mov_b32 v58, 0
    v_mov_b32 v59, 0
    v_mov_b32 v60, 0
    v_mov_b32 v61, 0
    v_mov_b32 v62, 0
    v_mov_b32 v63, 0
    v_mov_b32 v64, 0
    v_mov_b32 v65, 0
    v_mov_b32 v66, 0
    v_mov_b32 v67, 0
    v_mov_b32 v68, 0
    v_mov_b32 v69, 0
    v_mov_b32 v70, 0
    v_mov_b32 v71, 0
    v_mov_b32 v72, 0
    v_mov_b32 v73, 0
    v_mov_b32 v74, 0
    v_mov_b32 v75, 0
    v_mov_b32 v76, 0
    v_mov_b32 v77, 0
    v_mov_b32 v78, 0
    v_mov_b32 v79, 0
    v_mov_b32 v80, 0
    v_mov_b32 v81, 0
    v_mov_b32 v82, 0
    v_mov_b32 v83, 0
    v_mov_b32 v84, 0
    v_mov_b32 v85, 0
    v_mov_b32 v86, 0
    v_mov_b32 v87, 0
    v_mov_b32 v88, 0
    v_mov_b32 v89, 0
    v_mov_b32 v90, 0
    v_mov_b32 v91, 0
    v_mov_b32 v92, 0
    v_mov_b32 v93, 0
    v_mov_b32 v94, 0
    v_mov_b32 v95, 0
    v_mov_b32 v96, 0
    v_mov_b32 v97, 0
    v_mov_b32 v98, 0
    v_mov_b32 v99, 0
    v_mov_b32 v100, 0
    v_mov_b32 v101, 0
    v_mov_b32 v102, 0
    v_mov_b32 v103, 0
    v_mov_b32 v104, 0
    v_mov_b32 v105, 0
    v_mov_b32 v106, 0
    v_mov_b32 v107, 0
    v_mov_b32 v108, 0
    v_mov_b32 v109, 0
    v_mov_b32 v110, 0
    v_mov_b32 v111, 0
    s_and_b32 s12, s3, 1
    s_xor_b32 s12, s12, 1
    s_lshl_b32 s12, s12, 4
    s_add_u32 s12, s12, s60
    s_mul_i32 s26, s12, 36864
    s_mov_b32 s27, 0
    s_add_u32 m0, s70, 0
    s_nop 0
    buffer_load_dwordx4 v244, s[44:47], s71 offen offset:0 lds
    buffer_load_dwordx4 v245, s[44:47], s71 offen offset:1024 lds
    buffer_load_dwordx4 v246, s[44:47], s71 offen offset:2048 lds
    buffer_load_dwordx4 v247, s[44:47], s71 offen offset:3072 lds
    s_add_u32 s71, s71, 327680
    buffer_load_dwordx4 v[112:115], v248, s[40:43], s64 offen
    s_add_u32 s64, s64, 73728
    buffer_load_dwordx4 v[116:119], v248, s[40:43], s65 offen
    s_add_u32 s65, s65, 73728
    buffer_load_dwordx4 v[120:123], v248, s[40:43], s66 offen
    s_add_u32 s66, s66, 73728
    buffer_load_dwordx4 v[124:127], v248, s[40:43], s67 offen
    s_add_u32 s67, s67, 73728
    buffer_load_dwordx4 v[128:131], v248, s[40:43], s68 offen
    s_add_u32 s68, s68, 73728
    buffer_load_dwordx4 v[132:135], v248, s[40:43], s69 offen
    s_add_u32 s69, s69, 73728
    s_add_u32 m0, s70, 4096
    s_nop 0
    buffer_load_dwordx4 v244, s[44:47], s71 offen offset:0 lds
    buffer_load_dwordx4 v245, s[44:47], s71 offen offset:1024 lds
    buffer_load_dwordx4 v246, s[44:47], s71 offen offset:2048 lds
    buffer_load_dwordx4 v247, s[44:47], s71 offen offset:3072 lds
    s_add_u32 s71, s71, 327680
    buffer_load_dwordx4 v[136:139], v248, s[40:43], s64 offen
    s_add_u32 s64, s64, 73728
    buffer_load_dwordx4 v[140:143], v248, s[40:43], s65 offen
    s_add_u32 s65, s65, 73728
    buffer_load_dwordx4 v[144:147], v248, s[40:43], s66 offen
    s_add_u32 s66, s66, 73728
    buffer_load_dwordx4 v[148:151], v248, s[40:43], s67 offen
    s_add_u32 s67, s67, 73728
    buffer_load_dwordx4 v[152:155], v248, s[40:43], s68 offen
    s_add_u32 s68, s68, 73728
    buffer_load_dwordx4 v[156:159], v248, s[40:43], s69 offen
    s_add_u32 s69, s69, 73728
    s_add_u32 m0, s70, 8192
    s_nop 0
    buffer_load_dwordx4 v244, s[44:47], s71 offen offset:0 lds
    buffer_load_dwordx4 v245, s[44:47], s71 offen offset:1024 lds
    buffer_load_dwordx4 v246, s[44:47], s71 offen offset:2048 lds
    buffer_load_dwordx4 v247, s[44:47], s71 offen offset:3072 lds
    s_add_u32 s71, s71, 327680
    buffer_load_dwordx4 v[160:163], v248, s[40:43], s64 offen
    s_add_u32 s64, s64, 73728
    buffer_load_dwordx4 v[164:167], v248, s[40:43], s65 offen
    s_add_u32 s65, s65, 73728
    buffer_load_dwordx4 v[168:171], v248, s[40:43], s66 offen
    s_add_u32 s66, s66, 73728
    buffer_load_dwordx4 v[172:175], v248, s[40:43], s67 offen
    s_add_u32 s67, s67, 73728
    buffer_load_dwordx4 v[176:179], v248, s[40:43], s68 offen
    s_add_u32 s68, s68, 73728
    buffer_load_dwordx4 v[180:183], v248, s[40:43], s69 offen
    s_add_u32 s69, s69, 73728
    s_waitcnt vmcnt(26)
    ds_read_b64_tr_b16 v[208:209], v240 offset:0
    ds_read_b64_tr_b16 v[210:211], v240 offset:2048
    ds_read_b64_tr_b16 v[212:213], v241 offset:0
    ds_read_b64_tr_b16 v[214:215], v241 offset:2048
    ds_read_b64_tr_b16 v[216:217], v242 offset:0
    ds_read_b64_tr_b16 v[218:219], v242 offset:2048
    ds_read_b64_tr_b16 v[220:221], v243 offset:0
    ds_read_b64_tr_b16 v[222:223], v243 offset:2048
    s_mov_b32 s61, 4
    s_nop 7
L_k2_loop:
    s_add_u32 m0, s70, 12288
    s_nop 0
    buffer_load_dwordx4 v244, s[44:47], s71 offen offset:0 lds
    buffer_load_dwordx4 v245, s[44:47], s71 offen offset:1024 lds
    buffer_load_dwordx4 v246, s[44:47], s71 offen offset:2048 lds
    buffer_load_dwordx4 v247, s[44:47], s71 offen offset:3072 lds
    s_add_u32 s71, s71, 327680
    buffer_load_dwordx4 v[184:187], v248, s[40:43], s64 offen
    s_add_u32 s64, s64, 73728
    buffer_load_dwordx4 v[188:191], v248, s[40:43], s65 offen
    s_add_u32 s65, s65, 73728
    buffer_load_dwordx4 v[192:195], v248, s[40:43], s66 offen
    s_add_u32 s66, s66, 73728
    buffer_load_dwordx4 v[196:199], v248, s[40:43], s67 offen
    s_add_u32 s67, s67, 73728
    buffer_load_dwordx4 v[200:203], v248, s[40:43], s68 offen
    s_add_u32 s68, s68, 73728
    buffer_load_dwordx4 v[204:207], v248, s[40:43], s69 offen
    s_add_u32 s69, s69, 73728
    s_waitcnt vmcnt(26)
    ds_read_b64_tr_b16 v[224:225], v240 offset:4096
    ds_read_b64_tr_b16 v[226:227], v240 offset:6144
    ds_read_b64_tr_b16 v[228:229], v241 offset:4096
    ds_read_b64_tr_b16 v[230:231], v241 offset:6144
    ds_read_b64_tr_b16 v[232:233], v242 offset:4096
    ds_read_b64_tr_b16 v[234:235], v242 offset:6144
    ds_read_b64_tr_b16 v[236:237], v243 offset:4096
    ds_read_b64_tr_b16 v[238:239], v243 offset:6144
    s_waitcnt lgkmcnt(14)
    v_mfma_f32_16x16x32_bf16 v[16:19], v[208:211], v[112:115], v[16:19]
    v_mfma_f32_16x16x32_bf16 v[20:23], v[208:211], v[116:119], v[20:23]
    v_mfma_f32_16x16x32_bf16 v[24:27], v[208:211], v[120:123], v[24:27]
    v_mfma_f32_16x16x32_bf16 v[28:31], v[208:211], v[124:127], v[28:31]
    v_mfma_f32_16x16x32_bf16 v[32:35], v[208:211], v[128:131], v[32:35]
    v_mfma_f32_16x16x32_bf16 v[36:39], v[208:211], v[132:135], v[36:39]
    s_waitcnt lgkmcnt(12)
    v_mfma_f32_16x16x32_bf16 v[40:43], v[212:215], v[112:115], v[40:43]
    v_mfma_f32_16x16x32_bf16 v[44:47], v[212:215], v[116:119], v[44:47]
    v_mfma_f32_16x16x32_bf16 v[48:51], v[212:215], v[120:123], v[48:51]
    v_mfma_f32_16x16x32_bf16 v[52:55], v[212:215], v[124:127], v[52:55]
    v_mfma_f32_16x16x32_bf16 v[56:59], v[212:215], v[128:131], v[56:59]
    v_mfma_f32_16x16x32_bf16 v[60:63], v[212:215], v[132:135], v[60:63]
    s_waitcnt lgkmcnt(10)
    v_mfma_f32_16x16x32_bf16 v[64:67], v[216:219], v[112:115], v[64:67]
    v_mfma_f32_16x16x32_bf16 v[68:71], v[216:219], v[116:119], v[68:71]
    v_mfma_f32_16x16x32_bf16 v[72:75], v[216:219], v[120:123], v[72:75]
    v_mfma_f32_16x16x32_bf16 v[76:79], v[216:219], v[124:127], v[76:79]
    v_mfma_f32_16x16x32_bf16 v[80:83], v[216:219], v[128:131], v[80:83]
    v_mfma_f32_16x16x32_bf16 v[84:87], v[216:219], v[132:135], v[84:87]
    s_waitcnt lgkmcnt(8)
    v_mfma_f32_16x16x32_bf16 v[88:91], v[220:223], v[112:115], v[88:91]
    v_mfma_f32_16x16x32_bf16 v[92:95], v[220:223], v[116:119], v[92:95]
    v_mfma_f32_16x16x32_bf16 v[96:99], v[220:223], v[120:123], v[96:99]
    v_mfma_f32_16x16x32_bf16 v[100:103], v[220:223], v[124:127], v[100:103]
    v_mfma_f32_16x16x32_bf16 v[104:107], v[220:223], v[128:131], v[104:107]
    v_mfma_f32_16x16x32_bf16 v[108:111], v[220:223], v[132:135], v[108:111]
    s_add_u32 m0, s70, 0
    s_nop 0
    buffer_load_dwordx4 v244, s[44:47], s71 offen offset:0 lds
    buffer_load_dwordx4 v245, s[44:47], s71 offen offset:1024 lds
    buffer_load_dwordx4 v246, s[44:47], s71 offen offset:2048 lds
    buffer_load_dwordx4 v247, s[44:47], s71 offen offset:3072 lds
    s_add_u32 s71, s71, 327680
    buffer_load_dwordx4 v[112:115], v248, s[40:43], s64 offen
    s_add_u32 s64, s64, 73728
    buffer_load_dwordx4 v[116:119], v248, s[40:43], s65 offen
    s_add_u32 s65, s65, 73728
    buffer_load_dwordx4 v[120:123], v248, s[40:43], s66 offen
    s_add_u32 s66, s66, 73728
    buffer_load_dwordx4 v[124:127], v248, s[40:43], s67 offen
    s_add_u32 s67, s67, 73728
    buffer_load_dwordx4 v[128:131], v248, s[40:43], s68 offen
    s_add_u32 s68, s68, 73728
    buffer_load_dwordx4 v[132:135], v248, s[40:43], s69 offen
    s_add_u32 s69, s69, 73728
    s_waitcnt vmcnt(26)
    ds_read_b64_tr_b16 v[208:209], v240 offset:8192
    ds_read_b64_tr_b16 v[210:211], v240 offset:10240
    ds_read_b64_tr_b16 v[212:213], v241 offset:8192
    ds_read_b64_tr_b16 v[214:215], v241 offset:10240
    ds_read_b64_tr_b16 v[216:217], v242 offset:8192
    ds_read_b64_tr_b16 v[218:219], v242 offset:10240
    ds_read_b64_tr_b16 v[220:221], v243 offset:8192
    ds_read_b64_tr_b16 v[222:223], v243 offset:10240
    s_waitcnt lgkmcnt(14)
    v_mfma_f32_16x16x32_bf16 v[16:19], v[224:227], v[136:139], v[16:19]
    v_mfma_f32_16x16x32_bf16 v[20:23], v[224:227], v[140:143], v[20:23]
    v_mfma_f32_16x16x32_bf16 v[24:27], v[224:227], v[144:147], v[24:27]
    v_mfma_f32_16x16x32_bf16 v[28:31], v[224:227], v[148:151], v[28:31]
    v_mfma_f32_16x16x32_bf16 v[32:35], v[224:227], v[152:155], v[32:35]
    v_mfma_f32_16x16x32_bf16 v[36:39], v[224:227], v[156:159], v[36:39]
    s_waitcnt lgkmcnt(12)
    v_mfma_f32_16x16x32_bf16 v[40:43], v[228:231], v[136:139], v[40:43]
    v_mfma_f32_16x16x32_bf16 v[44:47], v[228:231], v[140:143], v[44:47]
    v_mfma_f32_16x16x32_bf16 v[48:51], v[228:231], v[144:147], v[48:51]
    v_mfma_f32_16x16x32_bf16 v[52:55], v[228:231], v[148:151], v[52:55]
    v_mfma_f32_16x16x32_bf16 v[56:59], v[228:231], v[152:155], v[56:59]
    v_mfma_f32_16x16x32_bf16 v[60:63], v[228:231], v[156:159], v[60:63]
    s_waitcnt lgkmcnt(10)
    v_mfma_f32_16x16x32_bf16 v[64:67], v[232:235], v[136:139], v[64:67]
    v_mfma_f32_16x16x32_bf16 v[68:71], v[232:235], v[140:143], v[68:71]
    v_mfma_f32_16x16x32_bf16 v[72:75], v[232:235], v[144:147], v[72:75]
    v_mfma_f32_16x16x32_bf16 v[76:79], v[232:235], v[148:151], v[76:79]
    v_mfma_f32_16x16x32_bf16 v[80:83], v[232:235], v[152:155], v[80:83]
    v_mfma_f32_16x16x32_bf16 v[84:87], v[232:235], v[156:159], v[84:87]
    s_waitcnt lgkmcnt(8)
    v_mfma_f32_16x16x32_bf16 v[88:91], v[236:239], v[136:139], v[88:91]
    v_mfma_f32_16x16x32_bf16 v[92:95], v[236:239], v[140:143], v[92:95]
    v_mfma_f32_16x16x32_bf16 v[96:99], v[236:239], v[144:147], v[96:99]
    v_mfma_f32_16x16x32_bf16 v[100:103], v[236:239], v[148:151], v[100:103]
    v_mfma_f32_16x16x32_bf16 v[104:107], v[236:239], v[152:155], v[104:107]
    v_mfma_f32_16x16x32_bf16 v[108:111], v[236:239], v[156:159], v[108:111]
    s_add_u32 m0, s70, 4096
    s_nop 0
    buffer_load_dwordx4 v244, s[44:47], s71 offen offset:0 lds
    buffer_load_dwordx4 v245, s[44:47], s71 offen offset:1024 lds
    buffer_load_dwordx4 v246, s[44:47], s71 offen offset:2048 lds
    buffer_load_dwordx4 v247, s[44:47], s71 offen offset:3072 lds
    s_add_u32 s71, s71, 327680
    buffer_load_dwordx4 v[136:139], v248, s[40:43], s64 offen
    s_add_u32 s64, s64, 73728
    buffer_load_dwordx4 v[140:143], v248, s[40:43], s65 offen
    s_add_u32 s65, s65, 73728
    buffer_load_dwordx4 v[144:147], v248, s[40:43], s66 offen
    s_add_u32 s66, s66, 73728
    buffer_load_dwordx4 v[148:151], v248, s[40:43], s67 offen
    s_add_u32 s67, s67, 73728
    buffer_load_dwordx4 v[152:155], v248, s[40:43], s68 offen
    s_add_u32 s68, s68, 73728
    buffer_load_dwordx4 v[156:159], v248, s[40:43], s69 offen
    s_add_u32 s69, s69, 73728
    s_waitcnt vmcnt(26)
    ds_read_b64_tr_b16 v[224:225], v240 offset:12288
    ds_read_b64_tr_b16 v[226:227], v240 offset:14336
    ds_read_b64_tr_b16 v[228:229], v241 offset:12288
    ds_read_b64_tr_b16 v[230:231], v241 offset:14336
    ds_read_b64_tr_b16 v[232:233], v242 offset:12288
    ds_read_b64_tr_b16 v[234:235], v242 offset:14336
    ds_read_b64_tr_b16 v[236:237], v243 offset:12288
    ds_read_b64_tr_b16 v[238:239], v243 offset:14336
    s_waitcnt lgkmcnt(14)
    v_mfma_f32_16x16x32_bf16 v[16:19], v[208:211], v[160:163], v[16:19]
    v_mfma_f32_16x16x32_bf16 v[20:23], v[208:211], v[164:167], v[20:23]
    v_mfma_f32_16x16x32_bf16 v[24:27], v[208:211], v[168:171], v[24:27]
    v_mfma_f32_16x16x32_bf16 v[28:31], v[208:211], v[172:175], v[28:31]
    v_mfma_f32_16x16x32_bf16 v[32:35], v[208:211], v[176:179], v[32:35]
    v_mfma_f32_16x16x32_bf16 v[36:39], v[208:211], v[180:183], v[36:39]
    s_waitcnt lgkmcnt(12)
    v_mfma_f32_16x16x32_bf16 v[40:43], v[212:215], v[160:163], v[40:43]
    v_mfma_f32_16x16x32_bf16 v[44:47], v[212:215], v[164:167], v[44:47]
    v_mfma_f32_16x16x32_bf16 v[48:51], v[212:215], v[168:171], v[48:51]
    v_mfma_f32_16x16x32_bf16 v[52:55], v[212:215], v[172:175], v[52:55]
    v_mfma_f32_16x16x32_bf16 v[56:59], v[212:215], v[176:179], v[56:59]
    v_mfma_f32_16x16x32_bf16 v[60:63], v[212:215], v[180:183], v[60:63]
    s_waitcnt lgkmcnt(10)
    v_mfma_f32_16x16x32_bf16 v[64:67], v[216:219], v[160:163], v[64:67]
    v_mfma_f32_16x16x32_bf16 v[68:71], v[216:219], v[164:167], v[68:71]
    v_mfma_f32_16x16x32_bf16 v[72:75], v[216:219], v[168:171], v[72:75]
    v_mfma_f32_16x16x32_bf16 v[76:79], v[216:219], v[172:175], v[76:79]
    v_mfma_f32_16x16x32_bf16 v[80:83], v[216:219], v[176:179], v[80:83]
    v_mfma_f32_16x16x32_bf16 v[84:87], v[216:219], v[180:183], v[84:87]
    s_waitcnt lgkmcnt(8)
    v_mfma_f32_16x16x32_bf16 v[88:91], v[220:223], v[160:163], v[88:91]
    v_mfma_f32_16x16x32_bf16 v[92:95], v[220:223], v[164:167], v[92:95]
    v_mfma_f32_16x16x32_bf16 v[96:99], v[220:223], v[168:171], v[96:99]
    v_mfma_f32_16x16x32_bf16 v[100:103], v[220:223], v[172:175], v[100:103]
    v_mfma_f32_16x16x32_bf16 v[104:107], v[220:223], v[176:179], v[104:107]
    v_mfma_f32_16x16x32_bf16 v[108:111], v[220:223], v[180:183], v[108:111]
    s_add_u32 m0, s70, 8192
    s_nop 0
    buffer_load_dwordx4 v244, s[44:47], s71 offen offset:0 lds
    buffer_load_dwordx4 v245, s[44:47], s71 offen offset:1024 lds
    buffer_load_dwordx4 v246, s[44:47], s71 offen offset:2048 lds
    buffer_load_dwordx4 v247, s[44:47], s71 offen offset:3072 lds
    s_add_u32 s71, s71, 327680
    buffer_load_dwordx4 v[160:163], v248, s[40:43], s64 offen
    s_add_u32 s64, s64, 73728
    buffer_load_dwordx4 v[164:167], v248, s[40:43], s65 offen
    s_add_u32 s65, s65, 73728
    buffer_load_dwordx4 v[168:171], v248, s[40:43], s66 offen
    s_add_u32 s66, s66, 73728
    buffer_load_dwordx4 v[172:175], v248, s[40:43], s67 offen
    s_add_u32 s67, s67, 73728
    buffer_load_dwordx4 v[176:179], v248, s[40:43], s68 offen
    s_add_u32 s68, s68, 73728
    buffer_load_dwordx4 v[180:183], v248, s[40:43], s69 offen
    s_add_u32 s69, s69, 73728
    s_waitcnt vmcnt(26)
    ds_read_b64_tr_b16 v[208:209], v240 offset:0
    ds_read_b64_tr_b16 v[210:211], v240 offset:2048
    ds_read_b64_tr_b16 v[212:213], v241 offset:0
    ds_read_b64_tr_b16 v[214:215], v241 offset:2048
    ds_read_b64_tr_b16 v[216:217], v242 offset:0
    ds_read_b64_tr_b16 v[218:219], v242 offset:2048
    ds_read_b64_tr_b16 v[220:221], v243 offset:0
    ds_read_b64_tr_b16 v[222:223], v243 offset:2048
    s_waitcnt lgkmcnt(14)
    v_mfma_f32_16x16x32_bf16 v[16:19], v[224:227], v[184:187], v[16:19]
    v_mfma_f32_16x16x32_bf16 v[20:23], v[224:227], v[188:191], v[20:23]
    v_mfma_f32_16x16x32_bf16 v[24:27], v[224:227], v[192:195], v[24:27]
    v_mfma_f32_16x16x32_bf16 v[28:31], v[224:227], v[196:199], v[28:31]
    v_mfma_f32_16x16x32_bf16 v[32:35], v[224:227], v[200:203], v[32:35]
    v_mfma_f32_16x16x32_bf16 v[36:39], v[224:227], v[204:207], v[36:39]
    s_waitcnt lgkmcnt(12)
    v_mfma_f32_16x16x32_bf16 v[40:43], v[228:231], v[184:187], v[40:43]
    v_mfma_f32_16x16x32_bf16 v[44:47], v[228:231], v[188:191], v[44:47]
    v_mfma_f32_16x16x32_bf16 v[48:51], v[228:231], v[192:195], v[48:51]
    v_mfma_f32_16x16x32_bf16 v[52:55], v[228:231], v[196:199], v[52:55]
    v_mfma_f32_16x16x32_bf16 v[56:59], v[228:231], v[200:203], v[56:59]
    v_mfma_f32_16x16x32_bf16 v[60:63], v[228:231], v[204:207], v[60:63]
    s_waitcnt lgkmcnt(10)
    v_mfma_f32_16x16x32_bf16 v[64:67], v[232:235], v[184:187], v[64:67]
    v_mfma_f32_16x16x32_bf16 v[68:71], v[232:235], v[188:191], v[68:71]
    v_mfma_f32_16x16x32_bf16 v[72:75], v[232:235], v[192:195], v[72:75]
    v_mfma_f32_16x16x32_bf16 v[76:79], v[232:235], v[196:199], v[76:79]
    v_mfma_f32_16x16x32_bf16 v[80:83], v[232:235], v[200:203], v[80:83]
    v_mfma_f32_16x16x32_bf16 v[84:87], v[232:235], v[204:207], v[84:87]
    s_waitcnt lgkmcnt(8)
    v_mfma_f32_16x16x32_bf16 v[88:91], v[236:239], v[184:187], v[88:91]
    v_mfma_f32_16x16x32_bf16 v[92:95], v[236:239], v[188:191], v[92:95]
    v_mfma_f32_16x16x32_bf16 v[96:99], v[236:239], v[192:195], v[96:99]
    v_mfma_f32_16x16x32_bf16 v[100:103], v[236:239], v[196:199], v[100:103]
    v_mfma_f32_16x16x32_bf16 v[104:107], v[236:239], v[200:203], v[104:107]
    v_mfma_f32_16x16x32_bf16 v[108:111], v[236:239], v[204:207], v[108:111]
    s_sub_u32 s61, s61, 1
    s_cmp_lg_u32 s61, 0
    s_nop 5
    s_cbranch_scc1 L_k2_loop
    s_waitcnt lgkmcnt(0)
    s_waitcnt vmcnt(0)
    s_barrier
    s_mul_i32 s12, s60, 12288
    v_add_u32 v13, s12, v248
    s_lshl_b32 s12, s60, 11
    v_add_u32 v12, s12, v248
    v_add_u32 v11, 49152, v12
    v_mul_u32_u24 v14, 2560, v2
    v_lshlrev_b32 v15, 3, v3
    v_add_u32 v14, v14, v15
    s_mul_i32 s13, s8, 6
    s_mul_i32 s14, s7, 1280
    s_lshl_b32 s15, s9, 7
    s_add_u32 s14, s14, s15
    ds_write_b128 v13, v[16:19] offset:0
    ds_write_b128 v13, v[20:23] offset:1024
    ds_write_b128 v13, v[24:27] offset:2048
    ds_write_b128 v13, v[28:31] offset:3072
    ds_write_b128 v13, v[32:35] offset:4096
    ds_write_b128 v13, v[36:39] offset:5120
    ds_write_b128 v13, v[40:43] offset:6144
    ds_write_b128 v13, v[44:47] offset:7168
    ds_write_b128 v13, v[48:51] offset:8192
    ds_write_b128 v13, v[52:55] offset:9216
    ds_write_b128 v13, v[56:59] offset:10240
    ds_write_b128 v13, v[60:63] offset:11264
    s_waitcnt lgkmcnt(0)
    s_barrier
    s_cmp_ge_u32 s60, 6
    s_cbranch_scc1 L_k2_skip0
    ds_read_b128 v[112:115], v12 offset:0
    ds_read_b128 v[116:119], v12 offset:12288
    ds_read_b128 v[120:123], v12 offset:24576
    ds_read_b128 v[124:127], v12 offset:36864
    ds_read_b128 v[128:131], v11 offset:0
    ds_read_b128 v[132:135], v11 offset:12288
    ds_read_b128 v[136:139], v11 offset:24576
    ds_read_b128 v[140:143], v11 offset:36864
    ds_read_b128 v[144:147], v12 offset:1024
    ds_read_b128 v[148:151], v12 offset:13312
    ds_read_b128 v[152:155], v12 offset:25600
    ds_read_b128 v[156:159], v12 offset:37888
    ds_read_b128 v[160:163], v11 offset:1024
    ds_read_b128 v[164:167], v11 offset:13312
    ds_read_b128 v[168:171], v11 offset:25600
    ds_read_b128 v[172:175], v11 offset:37888
    s_waitcnt lgkmcnt(14)
    v_add_f32 v112, v112, v116
    v_add_f32 v113, v113, v117
    v_add_f32 v114, v114, v118
    v_add_f32 v115, v115, v119
    s_waitcnt lgkmcnt(12)
    v_add_f32 v120, v120, v124
    v_add_f32 v121, v121, v125
    v_add_f32 v122, v122, v126
    v_add_f32 v123, v123, v127
    s_waitcnt lgkmcnt(10)
    v_add_f32 v128, v128, v132
    v_add_f32 v129, v129, v133
    v_add_f32 v130, v130, v134
    v_add_f32 v131, v131, v135
    s_waitcnt lgkmcnt(8)
    v_add_f32 v136, v136, v140
    v_add_f32 v137, v137, v141
    v_add_f32 v138, v138, v142
    v_add_f32 v139, v139, v143
    v_add_f32 v112, v112, v120
    v_add_f32 v113, v113, v121
    v_add_f32 v114, v114, v122
    v_add_f32 v115, v115, v123
    v_add_f32 v128, v128, v136
    v_add_f32 v129, v129, v137
    v_add_f32 v130, v130, v138
    v_add_f32 v131, v131, v139
    v_add_f32 v112, v112, v128
    v_add_f32 v113, v113, v129
    v_add_f32 v114, v114, v130
    v_add_f32 v115, v115, v131
    v_cvt_pk_bf16_f32 v112, v112, v113
    v_cvt_pk_bf16_f32 v113, v114, v115
    s_lshl_b32 s12, s60, 1
    s_add_u32 s12, s12, 0
    s_mul_i32 s15, s12, 43
    s_lshr_b32 s15, s15, 8
    s_mul_i32 s16, s15, 6
    s_sub_u32 s12, s12, s16
    s_add_u32 s12, s12, s13
    s_mul_i32 s12, s12, 40960
    s_lshl_b32 s15, s15, 5
    s_add_u32 s12, s12, s15
    s_add_u32 s12, s12, s14
    buffer_store_dwordx2 v[112:113], v14, s[48:51], s12 offen
    s_waitcnt lgkmcnt(6)
    v_add_f32 v144, v144, v148
    v_add_f32 v145, v145, v149
    v_add_f32 v146, v146, v150
    v_add_f32 v147, v147, v151
    s_waitcnt lgkmcnt(4)
    v_add_f32 v152, v152, v156
    v_add_f32 v153, v153, v157
    v_add_f32 v154, v154, v158
    v_add_f32 v155, v155, v159
    s_waitcnt lgkmcnt(2)
    v_add_f32 v160, v160, v164
    v_add_f32 v161, v161, v165
    v_add_f32 v162, v162, v166
    v_add_f32 v163, v163, v167
    s_waitcnt lgkmcnt(0)
    v_add_f32 v168, v168, v172
    v_add_f32 v169, v169, v173
    v_add_f32 v170, v170, v174
    v_add_f32 v171, v171, v175
    v_add_f32 v144, v144, v152
    v_add_f32 v145, v145, v153
    v_add_f32 v146, v146, v154
    v_add_f32 v147, v147, v155
    v_add_f32 v160, v160, v168
    v_add_f32 v161, v161, v169
    v_add_f32 v162, v162, v170
    v_add_f32 v163, v163, v171
    v_add_f32 v144, v144, v160
    v_add_f32 v145, v145, v161
    v_add_f32 v146, v146, v162
    v_add_f32 v147, v147, v163
    v_cvt_pk_bf16_f32 v144, v144, v145
    v_cvt_pk_bf16_f32 v145, v146, v147
    s_lshl_b32 s12, s60, 1
    s_add_u32 s12, s12, 1
    s_mul_i32 s15, s12, 43
    s_lshr_b32 s15, s15, 8
    s_mul_i32 s16, s15, 6
    s_sub_u32 s12, s12, s16
    s_add_u32 s12, s12, s13
    s_mul_i32 s12, s12, 40960
    s_lshl_b32 s15, s15, 5
    s_add_u32 s12, s12, s15
    s_add_u32 s12, s12, s14
    buffer_store_dwordx2 v[144:145], v14, s[48:51], s12 offen
L_k2_skip0:
    s_nop 3
    s_barrier
    ds_write_b128 v13, v[64:67] offset:0
    ds_write_b128 v13, v[68:71] offset:1024
    ds_write_b128 v13, v[72:75] offset:2048
    ds_write_b128 v13, v[76:79] offset:3072
    ds_write_b128 v13, v[80:83] offset:4096
    ds_write_b128 v13, v[84:87] offset:5120
    ds_write_b128 v13, v[88:91] offset:6144
    ds_write_b128 v13, v[92:95] offset:7168
    ds_write_b128 v13, v[96:99] offset:8192
    ds_write_b128 v13, v[100:103] offset:9216
    ds_write_b128 v13, v[104:107] offset:10240
    ds_write_b128 v13, v[108:111] offset:11264
    s_waitcnt lgkmcnt(0)
    s_barrier
    s_cmp_ge_u32 s60, 6
    s_cbranch_scc1 L_k2_skip1
    ds_read_b128 v[112:115], v12 offset:0
    ds_read_b128 v[116:119], v12 offset:12288
    ds_read_b128 v[120:123], v12 offset:24576
    ds_read_b128 v[124:127], v12 offset:36864
    ds_read_b128 v[128:131], v11 offset:0
    ds_read_b128 v[132:135], v11 offset:12288
    ds_read_b128 v[136:139], v11 offset:24576
    ds_read_b128 v[140:143], v11 offset:36864
    ds_read_b128 v[144:147], v12 offset:1024
    ds_read_b128 v[148:151], v12 offset:13312
    ds_read_b128 v[152:155], v12 offset:25600
    ds_read_b128 v[156:159], v12 offset:37888
    ds_read_b128 v[160:163], v11 offset:1024
    ds_read_b128 v[164:167], v11 offset:13312
    ds_read_b128 v[168:171], v11 offset:25600
    ds_read_b128 v[172:175], v11 offset:37888
    s_waitcnt lgkmcnt(14)
    v_add_f32 v112, v112, v116
    v_add_f32 v113, v113, v117
    v_add_f32 v114, v114, v118
    v_add_f32 v115, v115, v119
    s_waitcnt lgkmcnt(12)
    v_add_f32 v120, v120, v124
    v_add_f32 v121, v121, v125
    v_add_f32 v122, v122, v126
    v_add_f32 v123, v123, v127
    s_waitcnt lgkmcnt(10)
    v_add_f32 v128, v128, v132
    v_add_f32 v129, v129, v133
    v_add_f32 v130, v130, v134
    v_add_f32 v131, v131, v135
    s_waitcnt lgkmcnt(8)
    v_add_f32 v136, v136, v140
    v_add_f32 v137, v137, v141
    v_add_f32 v138, v138, v142
    v_add_f32 v139, v139, v143
    v_add_f32 v112, v112, v120
    v_add_f32 v113, v113, v121
    v_add_f32 v114, v114, v122
    v_add_f32 v115, v115, v123
    v_add_f32 v128, v128, v136
    v_add_f32 v129, v129, v137
    v_add_f32 v130, v130, v138
    v_add_f32 v131, v131, v139
    v_add_f32 v112, v112, v128
    v_add_f32 v113, v113, v129
    v_add_f32 v114, v114, v130
    v_add_f32 v115, v115, v131
    v_cvt_pk_bf16_f32 v112, v112, v113
    v_cvt_pk_bf16_f32 v113, v114, v115
    s_lshl_b32 s12, s60, 1
    s_add_u32 s12, s12, 12
    s_mul_i32 s15, s12, 43
    s_lshr_b32 s15, s15, 8
    s_mul_i32 s16, s15, 6
    s_sub_u32 s12, s12, s16
    s_add_u32 s12, s12, s13
    s_mul_i32 s12, s12, 40960
    s_lshl_b32 s15, s15, 5
    s_add_u32 s12, s12, s15
    s_add_u32 s12, s12, s14
    buffer_store_dwordx2 v[112:113], v14, s[48:51], s12 offen
    s_waitcnt lgkmcnt(6)
    v_add_f32 v144, v144, v148
    v_add_f32 v145, v145, v149
    v_add_f32 v146, v146, v150
    v_add_f32 v147, v147, v151
    s_waitcnt lgkmcnt(4)
    v_add_f32 v152, v152, v156
    v_add_f32 v153, v153, v157
    v_add_f32 v154, v154, v158
    v_add_f32 v155, v155, v159
    s_waitcnt lgkmcnt(2)
    v_add_f32 v160, v160, v164
    v_add_f32 v161, v161, v165
    v_add_f32 v162, v162, v166
    v_add_f32 v163, v163, v167
    s_waitcnt lgkmcnt(0)
    v_add_f32 v168, v168, v172
    v_add_f32 v169, v169, v173
    v_add_f32 v170, v170, v174
    v_add_f32 v171, v171, v175
    v_add_f32 v144, v144, v152
    v_add_f32 v145, v145, v153
    v_add_f32 v146, v146, v154
    v_add_f32 v147, v147, v155
    v_add_f32 v160, v160, v168
    v_add_f32 v161, v161, v169
    v_add_f32 v162, v162, v170
    v_add_f32 v163, v163, v171
    v_add_f32 v144, v144, v160
    v_add_f32 v145, v145, v161
    v_add_f32 v146, v146, v162
    v_add_f32 v147, v147, v163
    v_cvt_pk_bf16_f32 v144, v144, v145
    v_cvt_pk_bf16_f32 v145, v146, v147
    s_lshl_b32 s12, s60, 1
    s_add_u32 s12, s12, 13
    s_mul_i32 s15, s12, 43
    s_lshr_b32 s15, s15, 8
    s_mul_i32 s16, s15, 6
    s_sub_u32 s12, s12, s16
    s_add_u32 s12, s12, s13
    s_mul_i32 s12, s12, 40960
    s_lshl_b32 s15, s15, 5
    s_add_u32 s12, s12, s15
    s_add_u32 s12, s12, s14
    buffer_store_dwordx2 v[144:145], v14, s[48:51], s12 offen
L_k2_skip1:
    s_nop 3
    s_waitcnt vmcnt(0)
L_k2_end:
    s_endpgm
.section .rodata,"a"
.p2align 6
.amdhsa_kernel k1_attn_kernel
  .amdhsa_next_free_vgpr 256
  .amdhsa_next_free_sgpr 102
  .amdhsa_accum_offset 256
  .amdhsa_group_segment_fixed_size 0
  .amdhsa_kernarg_size 104
  .amdhsa_user_sgpr_count 2
  .amdhsa_user_sgpr_kernarg_segment_ptr 1
  .amdhsa_system_sgpr_workgroup_id_x 1
.end_amdhsa_kernel
.p2align 6
.amdhsa_kernel k2_oproj_kernel
  .amdhsa_next_free_vgpr 256
  .amdhsa_next_free_sgpr 102
  .amdhsa_accum_offset 256
  .amdhsa_group_segment_fixed_size 0
  .amdhsa_kernarg_size 104
  .amdhsa_user_sgpr_count 2
  .amdhsa_user_sgpr_kernarg_segment_ptr 1
  .amdhsa_system_sgpr_workgroup_id_x 1
.end_amdhsa_kernel
```
